```python
import torch

def _softmax(x, axis=-1):
    return torch.softmax(x, dim=axis)

def _gelu(x):
    return torch.nn.functional.gelu(x, approximate='tanh')

def _silu(x):
    return torch.nn.functional.silu(x)

def _sigmoid(x):
    return torch.sigmoid(x)

def _layernorm(x, axis=-1, eps=1e-05):
    m = x.mean(dim=axis, keepdim=True)
    v = x.var(dim=axis, keepdim=True, unbiased=False)
    return (x - m) / torch.sqrt(v + eps)

def _scatter_add(tgt, idx, src, axis=0):
    return tgt.clone().index_add_(axis, idx, src)

def _segment_sum(src, seg, n):
    out = torch.zeros((n,) + src.shape[1:], dtype=src.dtype)
    return out.index_add_(0, seg, src)

def _pad(x, pw):
    flat = tuple((v for pair in reversed(pw) for v in pair))
    return torch.nn.functional.pad(x, flat)
kernel_name = 'adaLN_cond__ssm_conv_h3__glu_gated_reglu__prompt'

def setup_inputs():

    _w = lambda a: (lambda t: t.to(torch.bfloat16) if t.is_floating_point() else t)(torch.as_tensor(a))

    def _A_setup():
        B, S, D = (1, 2048, 640)
        ks = 4
        return {'q': _w((lambda *s: torch.randn(*s, dtype=torch.bfloat16) * 0.05)(B, S, D)), 'k': _w((lambda *s: torch.randn(*s, dtype=torch.bfloat16) * 0.8)(B, S, D)), 'v': _w((lambda *s: torch.randn(*s, dtype=torch.bfloat16) * 0.8)(B, S, D)), 'shift_k': _w((lambda *s: torch.randn(*s, dtype=torch.bfloat16) * 0.8)(D, ks) * 0.5), 'ssm_k': _w((lambda *s: torch.randn(*s, dtype=torch.bfloat16) * 0.8)(D, S) * (1.0 / S ** 0.5)), 'ssm_D': _w((lambda *s: torch.randn(*s, dtype=torch.bfloat16) * 0.8)(D))}
    _A_in = _A_setup()

    def _B_setup():
        B, S, D, F = (1, 2048, 640, 1536)
        return {'x': _w((lambda *s: torch.randn(*s, dtype=torch.bfloat16) * 0.05)(B, S, D)), 'W_gate': _w((lambda *s: torch.randn(*s, dtype=torch.bfloat16) * 0.8)(D, F) * (2.0 / D) ** 0.5), 'W_up': _w((lambda *s: torch.randn(*s, dtype=torch.bfloat16) * 0.8)(D, F) * (2.0 / D) ** 0.5), 'W_down': _w((lambda *s: torch.randn(*s, dtype=torch.bfloat16) * 0.8)(F, D) * (1.0 / F) ** 0.5)}
    _B_in = _B_setup()
    return {'A_q': _A_in['q'], 'A_k': _A_in['k'], 'A_v': _A_in['v'], 'A_shift_k': _A_in['shift_k'], 'A_ssm_k': _A_in['ssm_k'], 'A_ssm_D': _A_in['ssm_D'], 'B_x': _B_in['x'], 'B_W_gate': _B_in['W_gate'], 'B_W_up': _B_in['W_up'], 'B_W_down': _B_in['W_down'], 'c': _w((lambda *s: torch.randn(*s, dtype=torch.bfloat16) * 0.2)(1, 640) * 8.0), 'w_mod': _w((lambda *s: torch.randn(*s, dtype=torch.bfloat16) * 0.2)(640, 6 * 640) * 640 ** (-0.5) * 8.0)}

def reference(A_q, A_k, A_v, A_shift_k, A_ssm_k, A_ssm_D, B_x, B_W_gate, B_W_up, B_W_down, c, w_mod):

    def _A_ref(q, k, v, shift_k, ssm_k, ssm_D):
        B, S, D = q.shape
        ks = shift_k.shape[-1]
        k_pad = _pad(k, ((0, 0), (ks - 1, 0), (0, 0)))
        k_shift = torch.zeros_like(k)
        for t in range(ks):
            k_shift = k_shift + k_pad[:, t:t + S, :] * shift_k[:, ks - 1 - t][None, None, :]
        kv = k_shift * v
        L = 2 * S
        kv_pad = _pad(kv, ((0, 0), (0, S), (0, 0)))
        kf_pad = _pad(ssm_k, ((0, 0), (0, S)))
        kv_f = (lambda x, axes=(-2, -1): torch.fft.rfft2(x.float(), dim=axes))(kv_pad[:, None, :, :], axes=(1, 2))
        kf_f = (lambda x, axes=(-2, -1): torch.fft.rfft2(x.float(), dim=axes))(kf_pad[:, None, :], axes=(1, 2))
        kf_f = (lambda x, *d: x.permute(*d))(kf_f, 1, 2, 0)
        y_f = kv_f * kf_f[None, :, :, :]
        y = (lambda x, s, axes=(-2, -1): torch.fft.irfft2(x, s=s, dim=axes).to(torch.bfloat16))(y_f, (1, L), axes=(1, 2))[:, 0, :S, :]
        y = y + kv * ssm_D[None, None, :]
        return q * y

    def _B_ref(x, W_gate, W_up, W_down):
        gate = torch.einsum('bsd,df->bsf', x, W_gate)
        up = torch.einsum('bsd,df->bsf', x, W_up)
        gate = gate * (lambda x, dt: x.to(dt))(gate > 0, gate.dtype)
        h = gate * up
        return torch.einsum('bsf,fd->bsd', h, W_down)
    x = A_q
    mod = (_silu(c) @ w_mod).reshape(c.shape[0], 6, 1, -1)
    sa, ca, ga, sb, cb, gb = (mod[:, 0].clone(), mod[:, 1].clone(), mod[:, 2].clone(), mod[:, 3].clone(), mod[:, 4].clone(), mod[:, 5].clone())
    h = _layernorm(x, axis=-1) * (1 + ca) + sa
    x = x + ga * _A_ref(h, A_k, A_v, A_shift_k, A_ssm_k, A_ssm_D)
    h = _layernorm(x, axis=-1) * (1 + cb) + sb
    x = x + gb * _B_ref(h, B_W_gate, B_W_up, B_W_down)
    return x
```

```asm
; @launch grid=(256,1,1) block=(256,1,1) lds=163840
.amdgcn_target "amdgcn-amd-amdhsa--gfx950"
.text
.globl adaLN_cond__ssm_conv_h3__glu_gated_reglu__prompt_kernel
.p2align 8
.type adaLN_cond__ssm_conv_h3__glu_gated_reglu__prompt_kernel,@function
adaLN_cond__ssm_conv_h3__glu_gated_reglu__prompt_kernel:
    s_cmp_ge_u32 s2, 256
    s_cbranch_scc1 Lend
    s_load_dwordx16 s[4:19], s[0:1], 0
    s_load_dwordx8 s[20:27], s[0:1], 64
    s_load_dwordx2 s[28:29], s[0:1], 96
    s_load_dwordx2 s[30:31], s[0:1], 112
    s_getpc_b64 s[56:57]
Lpc:
    s_lshr_b32 s50, s2, 3
    v_bfe_u32 v254, v0, 2, 4
    s_lshl_b32 s58, s50, 11
    v_lshl_add_u32 v254, v254, 7, s58
    global_load_dword v255, v254, s[56:57]
    v_lshrrev_b32 v5, 6, v0
    v_and_b32 v1, 63, v0
    s_and_b32 s49, s2, 7
    v_readfirstlane_b32 s44, v5
    v_lshlrev_b32 v4, 4, v1
    v_mov_b32 v5, 0x80000000
    v_cmp_gt_u32 vcc, 32, v0
    v_lshlrev_b32 v6, 2, v0
    s_cmp_ge_u32 s50, 20
    v_cndmask_b32 v3, v5, v6, vcc
    s_cbranch_scc1 LW
    s_and_b32 s52, s49, 1
    s_mul_i32 s52, s52, 5
    s_lshr_b32 s51, s50, 2
    s_add_u32 s52, s52, s51
    s_and_b32 s53, s49, 6
    s_lshl_b32 s53, s53, 1
    s_and_b32 s51, s50, 3
    s_add_u32 s53, s53, s51
    s_lshl_b32 s45, s52, 4
    s_add_u32 s45, s45, s53
    s_nop 0
    s_mul_i32 s51, s53, 163840
    s_lshl_b32 s54, s52, 7
    s_add_u32 s51, s51, s54
    v_lshrrev_b32 v248, 3, v0
    v_and_b32 v249, 7, v0
    v_mul_u32_u24 v28, 5120, v248
    v_lshl_add_u32 v28, v249, 4, v28
    v_add_u32 v28, s51, v28
    v_subrev_u32 v29, 3840, v28
    s_lshl_b32 s54, s52, 9
    v_lshl_add_u32 v30, v1, 3, s54
    v_and_b32 v252, 15, v0
    s_mul_i32 s51, s53, 40
    v_lshrrev_b32 v32, 5, v0
    v_add_u32 v32, s51, v32
    v_lshlrev_b32 v31, 1, v32
    s_lshl_b32 s51, s45, 3
    s_waitcnt lgkmcnt(0)
    s_mov_b32 s36, s6
    s_mov_b32 s37, s7
    s_mov_b32 s38, 2621440
    s_mov_b32 s39, 0x20000
    s_load_dword s46, s[30:31], 0
    s_load_dwordx2 s[14:15], s[14:15], s51
    global_load_dwordx2 v[80:81], v30, s[10:11]
    global_load_ushort v184, v31, s[24:25] offset:0
    global_load_ushort v185, v31, s[24:25] offset:16
    global_load_ushort v186, v31, s[24:25] offset:32
    global_load_ushort v187, v31, s[24:25] offset:48
    global_load_ushort v188, v31, s[24:25] offset:64
    buffer_load_dwordx4 v[36:39], v29, s[36:39], 0 offen offset:0
    buffer_load_dwordx4 v[40:43], v29, s[36:39], 0 offen offset:1280
    buffer_load_dwordx4 v[44:47], v29, s[36:39], 0 offen offset:2560
    buffer_load_dwordx4 v[48:51], v28, s[36:39], 0 offen offset:0
    buffer_load_dwordx4 v[52:55], v28, s[36:39], 0 offen offset:1280
    buffer_load_dwordx4 v[56:59], v28, s[36:39], 0 offen offset:2560
    buffer_load_dwordx4 v[60:63], v28, s[36:39], 0 offen offset:3840
    global_load_dwordx4 v[64:67], v28, s[8:9] offset:0 nt
    global_load_dwordx4 v[68:71], v28, s[8:9] offset:1280 nt
    global_load_dwordx4 v[72:75], v28, s[8:9] offset:2560 nt
    global_load_dwordx4 v[76:79], v28, s[8:9] offset:3840 nt
    v_mul_u32_u24 v30, 7680, v32
    v_lshl_add_u32 v30, v249, 4, v30
    s_lshl_b32 s51, s52, 7
    v_add_u32 v30, s51, v30
    v_bfe_u32 v31, v0, 3, 2
    v_cmp_eq_u32 vcc, 3, v31
    s_nop 1
    v_addc_co_u32 v251, vcc, 0, v31, vcc
    v_mul_u32_u24 v251, 1280, v251
    v_add_u32 v236, v30, v251
    v_mul_u32_u24 v251, 2560, v31
    v_add_u32 v251, 3840, v251
    v_add_u32 v30, v30, v251
    v_lshrrev_b32 v31, 1, v31
    v_lshl_add_u32 v237, v31, 31, v30
    s_mov_b32 s36, s26
    s_mov_b32 s37, s27
    s_mov_b32 s38, 4915200
    s_mov_b32 s39, 0x20000
    s_mov_b32 s32, s30
    s_mov_b32 s33, s31
    s_mov_b32 s34, 22298624
    s_mov_b32 s35, 0x20000
    s_lshl_b32 s72, s45, 2
    s_add_u32 s72, s72, s44
    s_lshl_b32 s72, s72, 12
    s_add_u32 s40, s12, s72
    s_addc_u32 s41, s13, 0
    s_mov_b32 s42, 4096
    s_mov_b32 s43, 0x20000
    v_subrev_u32 v242, 8, v4
    v_mov_b32 v228, 0
    v_mov_b32 v229, 0
    v_mov_b32 v230, 0
    v_mov_b32 v231, 0
    s_mul_i32 s54, s44, 4608
    s_add_u32 s54, s54, 66560
    v_lshl_add_u32 v251, v1, 3, s54
    ds_write_b64 v251, v[228:229]
    s_mul_i32 s55, s44, 16640
    v_bfe_u32 v251, v0, 1, 2
    v_mul_u32_u24 v251, 4160, v251
    v_and_b32 v28, 1, v0
    v_lshl_add_u32 v251, v28, 4, v251
    v_add_u32 v251, s55, v251
    ds_write_b128 v251, v[228:231] offset:4096
    v_lshrrev_b32 v251, 1, v248
    v_xor_b32 v251, v251, v249
    v_lshlrev_b32 v251, 4, v251
    v_and_b32 v28, 1, v248
    v_lshl_add_u32 v251, v28, 3, v251
    v_lshl_add_u32 v232, v249, 11, v251
    v_add_u32 v232, 101376, v232
    s_lshl_b32 s51, s44, 1
    v_xor_b32 v251, s51, v1
    s_lshl_b32 s51, s44, 12
    s_add_u32 s51, s51, 101376
    v_lshl_add_u32 v233, v251, 4, s51
    v_xor_b32 v234, 16, v233
    v_lshrrev_b32 v29, 4, v1
    v_lshlrev_b32 v251, 12, v29
    v_lshl_add_u32 v235, v252, 4, v251
    v_sub_u32 v251, 63, v1
    v_lshl_add_u32 v241, v251, 4, s55
    v_mov_b32 v250, v29
    v_sub_u32 v251, 15, v252
    v_and_b32 v28, 3, v251
    v_mul_u32_u24 v28, 4160, v28
    v_lshrrev_b32 v251, 2, v251
    v_lshl_add_u32 v28, v251, 3, v28
    v_lshl_add_u32 v28, v250, 4, v28
    v_add_u32 v28, s55, v28
    v_lshlrev_b32 v29, 5, v252
    v_lshl_add_u32 v29, v250, 4, v29
    v_add_u32 v29, s54, v29
    v_bfe_u32 v30, v252, 1, 2
    v_xor_b32 v30, v30, v250
    v_lshl_add_u32 v30, v252, 2, v30
    s_lshl_b32 s51, s44, 12
    s_add_u32 s51, s51, 84992
    v_lshl_add_u32 v30, v30, 4, s51
    v_lshrrev_b32 v251, 1, v0
    v_xor_b32 v251, v251, v250
    v_and_b32 v253, 1, v0
    v_lshlrev_b32 v253, 3, v253
    v_lshl_add_u32 v31, v251, 4, v253
    v_add_u32 v31, 84992, v31
    v_lshlrev_b32 v32, 4, v0
    s_lshl_b32 s51, s52, 4
    v_lshrrev_b32 v33, 2, v1
    v_add_u32 v33, s51, v33
    v_lshlrev_b32 v33, 7, v33
    v_lshrrev_b32 v251, 3, v0
    v_bfe_u32 v253, v0, 2, 1
    v_lshl_add_u32 v251, v253, 5, v251
    v_and_b32 v253, 3, v0
    v_lshl_add_u32 v251, v251, 2, v253
    v_lshlrev_b32 v251, 2, v251
    v_add_u32 v238, 89088, v251
    s_mul_i32 s51, s52, 49152
    s_lshl_b32 s56, s44, 13
    s_add_u32 s56, s56, s51
    s_lshl_b32 s57, s53, 9
    s_add_u32 s57, s57, s56
    v_lshl_add_u32 v239, v1, 3, s57
    s_lshr_b32 s57, s44, 1
    s_lshl_b32 s57, s57, 31
    s_add_u32 s57, s57, 32768
    v_add_u32 v240, s57, v239
    s_and_b32 s57, s44, 1
    s_add_u32 s57, s57, 4
    v_mov_b32 v251, s44
    v_mov_b32 v253, s57
    v_cmp_gt_u32 vcc, 32, v1
    s_nop 1
    v_cndmask_b32 v251, v253, v251, vcc
    v_bfe_u32 v253, v1, 1, 4
    v_lshl_add_u32 v35, v251, 4, v253
    v_lshlrev_b32 v35, 9, v35
    v_and_b32 v253, 1, v1
    v_lshl_add_u32 v35, v253, 4, v35
    s_lshl_b32 s57, s53, 5
    s_add_u32 s51, s51, s57
    v_add_u32 v35, s51, v35
    v_lshlrev_b32 v251, 4, v251
    v_lshl_add_u32 v251, v253, 3, v251
    v_and_b32 v253, 1, v250
    v_lshl_add_u32 v251, v253, 2, v251
    v_add_u32 v243, 109568, v251
    v_lshrrev_b32 v34, 2, v0
    v_lshlrev_b32 v34, 7, v34
    s_and_b32 s51, s49, 1
    s_lshl_b32 s51, s51, 3
    s_lshr_b32 s56, s50, 2
    s_add_u32 s51, s51, s56
    s_lshl_b32 s51, s51, 4
    s_lshr_b32 s56, s49, 1
    s_lshl_b32 s56, s56, 2
    s_add_u32 s51, s51, s56
    s_and_b32 s56, s50, 3
    s_add_u32 s51, s51, s56
    s_lshl_b32 s51, s51, 7
    s_lshl_b32 s56, s45, 7
    v_mov_b32 v160, 0x80000000
    v_lshrrev_b32 v161, 3, v0
    s_add_u32 s57, s56, 22020096
    v_cmp_eq_u32 vcc, 0, v161
    v_mov_b32 v162, s57
    s_nop 0
    v_cndmask_b32 v160, v160, v162, vcc
    s_add_u32 s57, s56, 22085632
    v_cmp_eq_u32 vcc, 1, v161
    v_mov_b32 v162, s57
    s_nop 0
    v_cndmask_b32 v160, v160, v162, vcc
    s_add_u32 s57, s56, 22106112
    v_cmp_eq_u32 vcc, 2, v161
    v_mov_b32 v162, s57
    s_nop 0
    v_cndmask_b32 v160, v160, v162, vcc
    s_add_u32 s57, s56, 434176
    v_cmp_eq_u32 vcc, 3, v161
    v_mov_b32 v162, s57
    s_nop 0
    v_cndmask_b32 v160, v160, v162, vcc
    s_add_u32 s57, s51, 22126592
    v_cmp_eq_u32 vcc, 4, v161
    v_mov_b32 v162, s57
    s_nop 0
    v_cndmask_b32 v160, v160, v162, vcc
    s_add_u32 s57, s51, 22159360
    v_cmp_eq_u32 vcc, 5, v161
    v_mov_b32 v162, s57
    s_nop 0
    v_cndmask_b32 v160, v160, v162, vcc
    s_add_u32 s57, s51, 22192128
    v_cmp_eq_u32 vcc, 6, v161
    v_mov_b32 v162, s57
    s_nop 0
    v_cndmask_b32 v160, v160, v162, vcc
    s_add_u32 s57, s51, 22261760
    v_cmp_eq_u32 vcc, 7, v161
    v_mov_b32 v162, s57
    s_nop 0
    v_cndmask_b32 v160, v160, v162, vcc
    s_add_u32 s57, s51, 21495808
    v_cmp_eq_u32 vcc, 8, v161
    v_mov_b32 v162, s57
    s_nop 0
    v_cndmask_b32 v160, v160, v162, vcc
    s_add_u32 s57, s51, 21528576
    v_cmp_eq_u32 vcc, 9, v161
    v_mov_b32 v162, s57
    s_nop 0
    v_cndmask_b32 v160, v160, v162, vcc
    v_and_b32 v161, 7, v0
    v_lshl_add_u32 v160, v161, 4, v160
    v_mov_b32 v164, 0
    v_mov_b32 v165, 0
    v_mov_b32 v166, 0
    v_mov_b32 v167, 0
    buffer_store_dwordx4 v[164:167], v160, s[32:35], 0 offen sc1
    s_mov_b32 s51, 524288
    buffer_store_dwordx2 v[164:165], v239, s[32:35], s51 offen sc1
    buffer_store_dwordx2 v[164:165], v240, s[32:35], s51 offen sc1
    v_and_b32 v251, 1, v1
    v_lshlrev_b32 v251, 4, v251
    s_lshl_b32 s51, s44, 10
    s_add_u32 s51, s51, 84992
    v_add_u32 v253, s51, v4
    v_lshl_add_u32 v248, v249, 7, s51
    s_waitcnt vmcnt(19)
    v_and_b32 v84, 0xffff, v80
    v_lshrrev_b32 v85, 16, v80
    v_and_b32 v86, 0xffff, v81
    v_lshrrev_b32 v87, 16, v81
    v_lshlrev_b32 v84, v251, v84
    v_lshlrev_b32 v85, v251, v85
    v_lshlrev_b32 v86, v251, v86
    v_lshlrev_b32 v87, v251, v87
    ds_write_b128 v253, v[84:87]
    ds_read_b128 v[96:99], v248 offset:0
    ds_read_b128 v[100:103], v248 offset:16
    ds_read_b128 v[104:107], v248 offset:32
    ds_read_b128 v[108:111], v248 offset:48
    ds_read_b128 v[112:115], v248 offset:64
    ds_read_b128 v[116:119], v248 offset:80
    ds_read_b128 v[120:123], v248 offset:96
    ds_read_b128 v[124:127], v248 offset:112
    s_waitcnt vmcnt(18)
    v_lshlrev_b32 v184, 16, v184
    s_waitcnt vmcnt(17)
    v_lshlrev_b32 v185, 16, v185
    s_waitcnt vmcnt(16)
    v_lshlrev_b32 v186, 16, v186
    s_waitcnt vmcnt(15)
    v_lshlrev_b32 v187, 16, v187
    s_waitcnt vmcnt(14)
    v_lshlrev_b32 v188, 16, v188
    v_mul_f32 v189, 0xbfb8aa3b, v184
    v_mul_f32 v190, 0xbfb8aa3b, v185
    v_mul_f32 v191, 0xbfb8aa3b, v186
    v_mul_f32 v192, 0xbfb8aa3b, v187
    v_mul_f32 v193, 0xbfb8aa3b, v188
    v_exp_f32 v189, v189
    v_exp_f32 v190, v190
    v_exp_f32 v191, v191
    v_exp_f32 v192, v192
    v_exp_f32 v193, v193
    v_add_f32 v189, 1.0, v189
    v_add_f32 v190, 1.0, v190
    v_add_f32 v191, 1.0, v191
    v_add_f32 v192, 1.0, v192
    v_add_f32 v193, 1.0, v193
    v_rcp_f32 v189, v189
    v_rcp_f32 v190, v190
    v_rcp_f32 v191, v191
    v_rcp_f32 v192, v192
    v_rcp_f32 v193, v193
    v_mul_f32 v189, v189, v184
    v_mul_f32 v190, v190, v185
    v_mul_f32 v191, v191, v186
    v_mul_f32 v192, v192, v187
    v_mul_f32 v193, v193, v188
    v_cvt_pk_bf16_f32 v189, v189, 0
    v_cvt_pk_bf16_f32 v190, v190, 0
    v_cvt_pk_bf16_f32 v191, v191, 0
    v_cvt_pk_bf16_f32 v192, v192, 0
    v_cvt_pk_bf16_f32 v193, v193, 0
    v_lshlrev_b32 v194, 16, v189
    v_lshlrev_b32 v195, 16, v190
    v_lshlrev_b32 v196, 16, v191
    v_lshlrev_b32 v197, 16, v192
    v_lshlrev_b32 v198, 16, v193
    s_mov_b32 s86, 61440
    s_mov_b32 s87, 122880
    s_mov_b32 s88, 184320
    s_mov_b32 s89, 245760
    s_waitcnt vmcnt(7)
    buffer_load_dwordx4 v[204:207], v236, s[36:39], 0 offen nt
    s_waitcnt lgkmcnt(0)
    v_dot2_f32_bf16 v128, v36, v99, 0
    v_dot2_f32_bf16 v129, v36, v103, 0
    v_dot2_f32_bf16 v130, v37, v107, 0
    v_dot2_f32_bf16 v131, v37, v111, 0
    v_dot2_f32_bf16 v132, v38, v115, 0
    v_dot2_f32_bf16 v133, v38, v119, 0
    v_dot2_f32_bf16 v134, v39, v123, 0
    v_dot2_f32_bf16 v135, v39, v127, 0
    v_dot2_f32_bf16 v128, v40, v98, v128
    v_dot2_f32_bf16 v129, v40, v102, v129
    v_dot2_f32_bf16 v130, v41, v106, v130
    v_dot2_f32_bf16 v131, v41, v110, v131
    v_dot2_f32_bf16 v132, v42, v114, v132
    v_dot2_f32_bf16 v133, v42, v118, v133
    v_dot2_f32_bf16 v134, v43, v122, v134
    v_dot2_f32_bf16 v135, v43, v126, v135
    v_dot2_f32_bf16 v128, v44, v97, v128
    v_dot2_f32_bf16 v129, v44, v101, v129
    v_dot2_f32_bf16 v130, v45, v105, v130
    v_dot2_f32_bf16 v131, v45, v109, v131
    v_dot2_f32_bf16 v132, v46, v113, v132
    v_dot2_f32_bf16 v133, v46, v117, v133
    v_dot2_f32_bf16 v134, v47, v121, v134
    v_dot2_f32_bf16 v135, v47, v125, v135
    v_dot2_f32_bf16 v128, v48, v96, v128
    v_dot2_f32_bf16 v129, v48, v100, v129
    buffer_load_dwordx4 v[208:211], v236, s[36:39], s86 offen nt
    v_dot2_f32_bf16 v130, v49, v104, v130
    v_dot2_f32_bf16 v131, v49, v108, v131
    v_dot2_f32_bf16 v132, v50, v112, v132
    v_dot2_f32_bf16 v133, v50, v116, v133
    v_dot2_f32_bf16 v134, v51, v120, v134
    v_dot2_f32_bf16 v135, v51, v124, v135
    v_dot2_f32_bf16 v136, v40, v99, 0
    v_dot2_f32_bf16 v137, v40, v103, 0
    v_dot2_f32_bf16 v138, v41, v107, 0
    v_dot2_f32_bf16 v139, v41, v111, 0
    v_dot2_f32_bf16 v140, v42, v115, 0
    v_dot2_f32_bf16 v141, v42, v119, 0
    v_dot2_f32_bf16 v142, v43, v123, 0
    v_dot2_f32_bf16 v143, v43, v127, 0
    v_dot2_f32_bf16 v136, v44, v98, v136
    v_dot2_f32_bf16 v137, v44, v102, v137
    v_dot2_f32_bf16 v138, v45, v106, v138
    v_dot2_f32_bf16 v139, v45, v110, v139
    v_dot2_f32_bf16 v140, v46, v114, v140
    v_dot2_f32_bf16 v141, v46, v118, v141
    v_dot2_f32_bf16 v142, v47, v122, v142
    v_dot2_f32_bf16 v143, v47, v126, v143
    v_dot2_f32_bf16 v136, v48, v97, v136
    v_dot2_f32_bf16 v137, v48, v101, v137
    v_dot2_f32_bf16 v138, v49, v105, v138
    v_dot2_f32_bf16 v139, v49, v109, v139
    buffer_load_dwordx4 v[212:215], v236, s[36:39], s87 offen nt
    v_dot2_f32_bf16 v140, v50, v113, v140
    v_dot2_f32_bf16 v141, v50, v117, v141
    v_dot2_f32_bf16 v142, v51, v121, v142
    v_dot2_f32_bf16 v143, v51, v125, v143
    v_dot2_f32_bf16 v136, v52, v96, v136
    v_dot2_f32_bf16 v137, v52, v100, v137
    v_dot2_f32_bf16 v138, v53, v104, v138
    v_dot2_f32_bf16 v139, v53, v108, v139
    v_dot2_f32_bf16 v140, v54, v112, v140
    v_dot2_f32_bf16 v141, v54, v116, v141
    v_dot2_f32_bf16 v142, v55, v120, v142
    v_dot2_f32_bf16 v143, v55, v124, v143
    v_dot2_f32_bf16 v144, v44, v99, 0
    v_dot2_f32_bf16 v145, v44, v103, 0
    v_dot2_f32_bf16 v146, v45, v107, 0
    v_dot2_f32_bf16 v147, v45, v111, 0
    v_dot2_f32_bf16 v148, v46, v115, 0
    v_dot2_f32_bf16 v149, v46, v119, 0
    v_dot2_f32_bf16 v150, v47, v123, 0
    v_dot2_f32_bf16 v151, v47, v127, 0
    v_dot2_f32_bf16 v144, v48, v98, v144
    v_dot2_f32_bf16 v145, v48, v102, v145
    v_dot2_f32_bf16 v146, v49, v106, v146
    v_dot2_f32_bf16 v147, v49, v110, v147
    v_dot2_f32_bf16 v148, v50, v114, v148
    buffer_load_dwordx4 v[216:219], v236, s[36:39], s88 offen nt
    v_dot2_f32_bf16 v149, v50, v118, v149
    v_dot2_f32_bf16 v150, v51, v122, v150
    v_dot2_f32_bf16 v151, v51, v126, v151
    v_dot2_f32_bf16 v144, v52, v97, v144
    v_dot2_f32_bf16 v145, v52, v101, v145
    v_dot2_f32_bf16 v146, v53, v105, v146
    v_dot2_f32_bf16 v147, v53, v109, v147
    v_dot2_f32_bf16 v148, v54, v113, v148
    v_dot2_f32_bf16 v149, v54, v117, v149
    v_dot2_f32_bf16 v150, v55, v121, v150
    v_dot2_f32_bf16 v151, v55, v125, v151
    v_dot2_f32_bf16 v144, v56, v96, v144
    v_dot2_f32_bf16 v145, v56, v100, v145
    v_dot2_f32_bf16 v146, v57, v104, v146
    v_dot2_f32_bf16 v147, v57, v108, v147
    v_dot2_f32_bf16 v148, v58, v112, v148
    v_dot2_f32_bf16 v149, v58, v116, v149
    v_dot2_f32_bf16 v150, v59, v120, v150
    v_dot2_f32_bf16 v151, v59, v124, v151
    v_dot2_f32_bf16 v152, v48, v99, 0
    v_dot2_f32_bf16 v153, v48, v103, 0
    v_dot2_f32_bf16 v154, v49, v107, 0
    v_dot2_f32_bf16 v155, v49, v111, 0
    v_dot2_f32_bf16 v156, v50, v115, 0
    v_dot2_f32_bf16 v157, v50, v119, 0
    v_dot2_f32_bf16 v158, v51, v123, 0
    buffer_load_dwordx4 v[220:223], v236, s[36:39], s89 offen nt
    v_dot2_f32_bf16 v159, v51, v127, 0
    v_dot2_f32_bf16 v152, v52, v98, v152
    v_dot2_f32_bf16 v153, v52, v102, v153
    v_dot2_f32_bf16 v154, v53, v106, v154
    v_dot2_f32_bf16 v155, v53, v110, v155
    v_dot2_f32_bf16 v156, v54, v114, v156
    v_dot2_f32_bf16 v157, v54, v118, v157
    v_dot2_f32_bf16 v158, v55, v122, v158
    v_dot2_f32_bf16 v159, v55, v126, v159
    v_dot2_f32_bf16 v152, v56, v97, v152
    v_dot2_f32_bf16 v153, v56, v101, v153
    v_dot2_f32_bf16 v154, v57, v105, v154
    v_dot2_f32_bf16 v155, v57, v109, v155
    v_dot2_f32_bf16 v156, v58, v113, v156
    v_dot2_f32_bf16 v157, v58, v117, v157
    v_dot2_f32_bf16 v158, v59, v121, v158
    v_dot2_f32_bf16 v159, v59, v125, v159
    v_dot2_f32_bf16 v152, v60, v96, v152
    v_dot2_f32_bf16 v153, v60, v100, v153
    v_dot2_f32_bf16 v154, v61, v104, v154
    v_dot2_f32_bf16 v155, v61, v108, v155
    v_dot2_f32_bf16 v156, v62, v112, v156
    v_dot2_f32_bf16 v157, v62, v116, v157
    v_dot2_f32_bf16 v158, v63, v120, v158
    v_dot2_f32_bf16 v159, v63, v124, v159
    s_waitcnt vmcnt(11)
    v_lshlrev_b32 v160, 16, v64
    v_and_b32 v161, 0xffff0000, v64
    v_lshlrev_b32 v162, 16, v65
    v_and_b32 v163, 0xffff0000, v65
    v_lshlrev_b32 v164, 16, v66
    v_and_b32 v165, 0xffff0000, v66
    v_lshlrev_b32 v166, 16, v67
    v_and_b32 v167, 0xffff0000, v67
    v_pk_mul_f32 v[128:129], v[128:129], v[160:161]
    v_pk_mul_f32 v[130:131], v[130:131], v[162:163]
    v_pk_mul_f32 v[132:133], v[132:133], v[164:165]
    v_pk_mul_f32 v[134:135], v[134:135], v[166:167]
    s_waitcnt vmcnt(10)
    v_lshlrev_b32 v160, 16, v68
    v_and_b32 v161, 0xffff0000, v68
    v_lshlrev_b32 v162, 16, v69
    v_and_b32 v163, 0xffff0000, v69
    v_lshlrev_b32 v164, 16, v70
    v_and_b32 v165, 0xffff0000, v70
    v_lshlrev_b32 v166, 16, v71
    v_and_b32 v167, 0xffff0000, v71
    v_pk_mul_f32 v[136:137], v[136:137], v[160:161]
    v_pk_mul_f32 v[138:139], v[138:139], v[162:163]
    v_pk_mul_f32 v[140:141], v[140:141], v[164:165]
    v_pk_mul_f32 v[142:143], v[142:143], v[166:167]
    s_waitcnt vmcnt(9)
    v_lshlrev_b32 v160, 16, v72
    v_and_b32 v161, 0xffff0000, v72
    v_lshlrev_b32 v162, 16, v73
    v_and_b32 v163, 0xffff0000, v73
    v_lshlrev_b32 v164, 16, v74
    v_and_b32 v165, 0xffff0000, v74
    v_lshlrev_b32 v166, 16, v75
    v_and_b32 v167, 0xffff0000, v75
    v_pk_mul_f32 v[144:145], v[144:145], v[160:161]
    v_pk_mul_f32 v[146:147], v[146:147], v[162:163]
    v_pk_mul_f32 v[148:149], v[148:149], v[164:165]
    v_pk_mul_f32 v[150:151], v[150:151], v[166:167]
    s_waitcnt vmcnt(8)
    v_lshlrev_b32 v160, 16, v76
    v_and_b32 v161, 0xffff0000, v76
    v_lshlrev_b32 v162, 16, v77
    v_and_b32 v163, 0xffff0000, v77
    v_lshlrev_b32 v164, 16, v78
    v_and_b32 v165, 0xffff0000, v78
    v_lshlrev_b32 v166, 16, v79
    v_and_b32 v167, 0xffff0000, v79
    v_pk_mul_f32 v[152:153], v[152:153], v[160:161]
    v_pk_mul_f32 v[154:155], v[154:155], v[162:163]
    v_pk_mul_f32 v[156:157], v[156:157], v[164:165]
    v_pk_mul_f32 v[158:159], v[158:159], v[166:167]
    v_cvt_pk_bf16_f32 v168, v128, v136
    v_cvt_pk_bf16_f32 v169, v144, v152
    ds_write_b64 v232, v[168:169] offset:0
    v_cvt_pk_bf16_f32 v170, v129, v137
    v_cvt_pk_bf16_f32 v171, v145, v153
    ds_write_b64 v232, v[170:171] offset:256
    v_cvt_pk_bf16_f32 v172, v130, v138
    v_cvt_pk_bf16_f32 v173, v146, v154
    ds_write_b64 v232, v[172:173] offset:512
    v_cvt_pk_bf16_f32 v174, v131, v139
    v_cvt_pk_bf16_f32 v175, v147, v155
    ds_write_b64 v232, v[174:175] offset:768
    v_cvt_pk_bf16_f32 v176, v132, v140
    v_cvt_pk_bf16_f32 v177, v148, v156
    ds_write_b64 v232, v[176:177] offset:1024
    v_cvt_pk_bf16_f32 v178, v133, v141
    v_cvt_pk_bf16_f32 v179, v149, v157
    ds_write_b64 v232, v[178:179] offset:1280
    v_cvt_pk_bf16_f32 v180, v134, v142
    v_cvt_pk_bf16_f32 v181, v150, v158
    ds_write_b64 v232, v[180:181] offset:1536
    v_cvt_pk_bf16_f32 v182, v135, v143
    v_cvt_pk_bf16_f32 v183, v151, v159
    ds_write_b64 v232, v[182:183] offset:1792
    s_lshl_b32 s51, s52, 18
    s_lshl_b32 s56, s44, 16
    s_add_u32 s51, s51, s56
    s_lshl_b32 s56, s53, 8
    s_add_u32 s56, s56, s51
    s_add_u32 s56, s56, 1048576
    s_waitcnt lgkmcnt(0)
    s_barrier
    ds_read_b128 v[36:39], v233 offset:0
    ds_read_b128 v[40:43], v233 offset:1024
    ds_read_b128 v[44:47], v234 offset:2048
    ds_read_b128 v[48:51], v234 offset:3072
    s_waitcnt lgkmcnt(3)
    buffer_store_dwordx4 v[36:39], v235, s[32:35], s56 offen sc1
    s_add_u32 s56, s56, 16384
    s_waitcnt lgkmcnt(2)
    buffer_store_dwordx4 v[40:43], v235, s[32:35], s56 offen sc1
    s_add_u32 s56, s56, 16384
    s_waitcnt lgkmcnt(1)
    buffer_store_dwordx4 v[44:47], v235, s[32:35], s56 offen sc1
    s_add_u32 s56, s56, 16384
    s_waitcnt lgkmcnt(0)
    buffer_store_dwordx4 v[48:51], v235, s[32:35], s56 offen sc1
    s_add_u32 s46, s46, 2654435769
    s_or_b32 s46, s46, 1
    v_mov_b32 v2, s46
    s_mov_b32 s55, 0xffff
    buffer_load_dwordx4 v[80:83], v237, s[36:39], 0 offen nt
    buffer_load_dwordx4 v[84:87], v237, s[36:39], s86 offen nt
    buffer_load_dwordx4 v[88:91], v237, s[36:39], s87 offen nt
    buffer_load_dwordx4 v[92:95], v237, s[36:39], s88 offen nt
    buffer_load_dwordx4 v[224:227], v237, s[36:39], s89 offen nt
    buffer_load_dwordx4 v[52:55], v4, s[40:43], 0 offen offset:0 nt
    buffer_load_dwordx2 v[68:69], v242, s[40:43], 0 offen nt
    buffer_load_dwordx4 v[56:59], v4, s[40:43], 0 offen offset:1024 nt
    buffer_load_dwordx2 v[70:71], v4, s[40:43], 0 offen offset:1016 nt
    buffer_load_dwordx4 v[60:63], v4, s[40:43], 0 offen offset:2048 nt
    buffer_load_dwordx2 v[72:73], v4, s[40:43], 0 offen offset:2040 nt
    buffer_load_dwordx4 v[64:67], v4, s[40:43], 0 offen offset:3072 nt
    buffer_load_dwordx2 v[74:75], v4, s[40:43], 0 offen offset:3064 nt
    v_mov_b32 v39, v243
    s_mov_b32 s58, 524288
    v_add_u32 v248, 89088, v32
    s_waitcnt vmcnt(21)
    v_dot2_f32_bf16 v96, v204, v189, 0
    v_dot2_f32_bf16 v97, v204, v194, 0
    v_dot2_f32_bf16 v98, v205, v189, 0
    v_dot2_f32_bf16 v99, v205, v194, 0
    v_dot2_f32_bf16 v100, v206, v189, 0
    v_dot2_f32_bf16 v101, v206, v194, 0
    v_dot2_f32_bf16 v102, v207, v189, 0
    v_dot2_f32_bf16 v103, v207, v194, 0
    s_waitcnt vmcnt(20)
    v_dot2_f32_bf16 v96, v208, v190, v96
    v_dot2_f32_bf16 v97, v208, v195, v97
    v_dot2_f32_bf16 v98, v209, v190, v98
    v_dot2_f32_bf16 v99, v209, v195, v99
    v_dot2_f32_bf16 v100, v210, v190, v100
    v_dot2_f32_bf16 v101, v210, v195, v101
    v_dot2_f32_bf16 v102, v211, v190, v102
    v_dot2_f32_bf16 v103, v211, v195, v103
    s_waitcnt vmcnt(19)
    v_dot2_f32_bf16 v96, v212, v191, v96
    v_dot2_f32_bf16 v97, v212, v196, v97
    v_dot2_f32_bf16 v98, v213, v191, v98
    v_dot2_f32_bf16 v99, v213, v196, v99
    v_dot2_f32_bf16 v100, v214, v191, v100
    v_dot2_f32_bf16 v101, v214, v196, v101
    v_dot2_f32_bf16 v102, v215, v191, v102
    v_dot2_f32_bf16 v103, v215, v196, v103
    s_waitcnt vmcnt(18)
    v_dot2_f32_bf16 v96, v216, v192, v96
    v_dot2_f32_bf16 v97, v216, v197, v97
    v_dot2_f32_bf16 v98, v217, v192, v98
    v_dot2_f32_bf16 v99, v217, v197, v99
    v_dot2_f32_bf16 v100, v218, v192, v100
    v_dot2_f32_bf16 v101, v218, v197, v101
    v_dot2_f32_bf16 v102, v219, v192, v102
    v_dot2_f32_bf16 v103, v219, v197, v103
    s_waitcnt vmcnt(17)
    v_dot2_f32_bf16 v96, v220, v193, v96
    v_dot2_f32_bf16 v97, v220, v198, v97
    v_dot2_f32_bf16 v98, v221, v193, v98
    v_dot2_f32_bf16 v99, v221, v198, v99
    v_dot2_f32_bf16 v100, v222, v193, v100
    v_dot2_f32_bf16 v101, v222, v198, v101
    v_dot2_f32_bf16 v102, v223, v193, v102
    v_dot2_f32_bf16 v103, v223, v198, v103
    v_permlane32_swap_b32 v96, v100
    v_permlane32_swap_b32 v97, v101
    v_permlane32_swap_b32 v98, v102
    v_permlane32_swap_b32 v99, v103
    v_add_f32 v96, v96, v100
    v_add_f32 v97, v97, v101
    v_add_f32 v98, v98, v102
    v_add_f32 v99, v99, v103
    ds_write_b128 v248, v[96:99] offset:0
    s_waitcnt vmcnt(13)
    s_waitcnt lgkmcnt(0)
    s_barrier
    s_lshl_b32 s51, s45, 7
    s_add_u32 s51, s51, 22020096
    buffer_store_dword v2, v3, s[32:35], s51 offen sc1
    s_add_u32 m0, s54, 512
    s_add_u32 s56, s72, 1048576
    s_lshl_b32 s52, s45, 14
    s_mov_b32 s80, s56
    s_mov_b32 s81, s57
    s_mov_b32 s82, s58
    v_mov_b32 v254, v248
    s_and_b32 s47, s49, 1
    s_lshl_b32 s47, s47, 3
    s_lshr_b32 s57, s50, 2
    s_add_u32 s47, s47, s57
    s_lshr_b32 s48, s49, 1
    s_lshl_b32 s48, s48, 2
    s_and_b32 s58, s50, 3
    s_add_u32 s48, s48, s58
    s_lshl_b32 s3, s47, 4
    s_add_u32 s3, s3, s48
    s_lshr_b32 s69, s48, 3
    s_lshl_b32 s69, s69, 2
    s_add_u32 s69, s69, s58
    s_lshl_b32 s58, s48, 2
    s_add_u32 s58, s58, s44
    s_mul_i32 s60, s58, 61440
    s_add_u32 s60, s60, 8912896
    s_mul_i32 s65, s69, 245760
    s_mul_i32 s51, s44, 61440
    s_add_u32 s65, s65, s51
    s_add_u32 s65, s65, 13107200
    s_mul_i32 s64, s47, 196608
    s_add_u32 s64, s64, 15204352
    s_bfe_u32 s57, s48, 0x10002
    s_mul_i32 s57, s57, 49152
    s_add_u32 s57, s57, s64
    s_mul_i32 s51, s44, 12288
    s_add_u32 s57, s57, s51
    s_lshr_b32 s51, s44, 1
    s_mul_i32 s51, s51, 98304
    s_add_u32 s67, s57, s51
    s_sub_u32 s57, s57, s51
    s_add_u32 s71, s57, 98304
    s_lshl_b32 s0, s44, 11
    s_lshl_b32 s51, s44, 17
    s_lshl_b32 s56, s47, 9
    s_add_u32 s51, s51, s56
    s_add_u32 s62, s51, 6291456
    s_lshl_b32 s70, s47, 11
    s_add_u32 s70, s70, 21495808
    v_and_b32 v244, 15, v1
    v_lshrrev_b32 v245, 4, v1
    v_add_u32 v5, 3072, v4
    v_add_u32 v6, 4096, v4
    s_lshr_b32 s51, s48, 2
    v_min_u32 v246, 19, v1
    v_lshl_add_u32 v246, v246, 2, s51
    v_lshlrev_b32 v15, 7, v246
    s_mul_i32 s51, s44, 24
    v_min_u32 v248, 23, v1
    v_add_u32 v248, s51, v248
    v_lshlrev_b32 v16, 7, v248
    v_bfe_u32 v17, v1, 2, 2
    v_mul_u32_u24 v17, 12288, v17
    v_lshl_add_u32 v17, v245, 4, v17
    s_mul_i32 s51, s58, 192
    v_add_u32 v17, s51, v17
    s_lshl_b32 s51, s47, 4
    s_lshl_b32 s56, s44, 2
    s_add_u32 s51, s51, s56
    v_add_u32 v18, s51, v245
    v_lshlrev_b32 v18, 7, v18
    v_min_u32 v14, 39, v1
    s_mul_i32 s51, s44, 40
    v_add_u32 v14, s51, v14
    v_lshlrev_b32 v14, 7, v14
    v_and_b32 v247, 1, v245
    v_and_b32 v248, 2, v245
    v_lshlrev_b32 v248, 5, v248
    v_lshl_add_u32 v248, v247, 7, v248
    v_lshlrev_b32 v246, 3, v244
    v_xor_b32 v246, v246, v248
    v_lshl_add_u32 v246, v245, 8, v246
    v_add_u32 v8, 122880, v246
    v_xor_b32 v9, 128, v8
    v_xor_b32 v22, 32, v8
    v_xor_b32 v23, 32, v9
    v_lshlrev_b32 v246, 4, v244
    v_xor_b32 v246, v246, v248
    s_and_b32 s51, s44, 1
    s_lshl_b32 s51, s51, 5
    v_xor_b32 v246, s51, v246
    v_lshl_add_u32 v10, v245, 14, v246
    v_add_u32 v11, 64512, v10
    v_lshrrev_b32 v246, 5, v1
    v_mul_u32_u24 v246, 49152, v246
    v_lshl_add_u32 v246, v244, 4, v246
    s_mul_i32 s51, s58, 768
    v_add_u32 v246, s51, v246
    v_cmp_eq_u32 vcc, 0, v247
    v_lshl_add_u32 v12, v247, 8, v246
    v_mov_b32 v248, 0x80000000
    v_cndmask_b32 v13, v248, v246, vcc
    s_and_b32 s51, s58, 31
    s_lshl_b32 s51, s51, 3
    v_and_b32 v246, 1, v1
    v_lshlrev_b32 v246, 7, v246
    v_and_b32 v247, 2, v1
    v_lshl_add_u32 v246, v247, 5, v246
    v_and_b32 v247, 8, v1
    v_lshl_add_u32 v246, v247, 2, v246
    v_xor_b32 v246, s51, v246
    v_lshl_add_u32 v19, v1, 8, v246
    s_cmp_lt_u32 s58, 32
    s_cselect_b32 s51, 0, 32
    s_cselect_b32 s56, 32, 0
    v_add_u32 v19, 122880, v19
    s_lshl_b32 s57, s51, 3
    s_add_u32 s90, s62, s57
    s_lshl_b32 s57, s56, 3
    s_add_u32 s91, s62, s57
    v_and_b32 v246, 60, v1
    v_add_u32 v246, v246, v1
    v_lshlrev_b32 v246, 4, v246
    s_lshl_b32 s92, s51, 5
    v_xor_b32 v21, s92, v246
    s_mul_i32 s57, s51, 3072
    s_add_u32 s94, s64, s57
    s_mul_i32 s57, s56, 3072
    s_add_u32 s95, s64, s57
    s_mul_i32 s96, s44, 10240
    s_lshl_b32 s51, s48, 7
    s_lshl_b32 s56, s44, 4
    s_add_u32 s51, s51, s56
    s_sub_u32 s51, s51, 3968
    v_lshl_add_u32 v246, v1, 6, s51
    v_mov_b32 v248, 0x80000000
    v_cmp_le_u32 vcc, 62, v1
    s_nop 1
    v_cndmask_b32 v20, v248, v246, vcc
    s_mov_b32 s56, s80
    s_mov_b32 s57, s81
    s_mov_b32 s58, s82
    v_mov_b32 v248, v254
    s_mov_b32 s99, 0
    s_mov_b64 exec, 0
    s_cmp_eq_u32 s44, 0
    s_cbranch_scc1 LhopC0
    s_cmp_eq_u32 s44, 1
    s_cbranch_scc1 LhopC1
    s_cmp_eq_u32 s44, 2
    s_cbranch_scc1 LhopC2
    s_branch LhopC3
LretC:
    s_waitcnt vmcnt(13)
    v_dot2_f32_bf16 v104, v80, v189, 0
    v_dot2_f32_bf16 v105, v80, v194, 0
    v_dot2_f32_bf16 v106, v81, v189, 0
    v_dot2_f32_bf16 v107, v81, v194, 0
    v_dot2_f32_bf16 v108, v82, v189, 0
    v_dot2_f32_bf16 v109, v82, v194, 0
    v_dot2_f32_bf16 v110, v83, v189, 0
    v_dot2_f32_bf16 v111, v83, v194, 0
    s_waitcnt vmcnt(12)
    v_dot2_f32_bf16 v104, v84, v190, v104
    v_dot2_f32_bf16 v105, v84, v195, v105
    v_dot2_f32_bf16 v106, v85, v190, v106
    v_dot2_f32_bf16 v107, v85, v195, v107
    v_dot2_f32_bf16 v108, v86, v190, v108
    v_dot2_f32_bf16 v109, v86, v195, v109
    v_dot2_f32_bf16 v110, v87, v190, v110
    v_dot2_f32_bf16 v111, v87, v195, v111
    s_waitcnt vmcnt(11)
    v_dot2_f32_bf16 v104, v88, v191, v104
    v_dot2_f32_bf16 v105, v88, v196, v105
    v_dot2_f32_bf16 v106, v89, v191, v106
    v_dot2_f32_bf16 v107, v89, v196, v107
    v_dot2_f32_bf16 v108, v90, v191, v108
    v_dot2_f32_bf16 v109, v90, v196, v109
    v_dot2_f32_bf16 v110, v91, v191, v110
    v_dot2_f32_bf16 v111, v91, v196, v111
    s_waitcnt vmcnt(10)
    v_dot2_f32_bf16 v104, v92, v192, v104
    v_dot2_f32_bf16 v105, v92, v197, v105
    v_dot2_f32_bf16 v106, v93, v192, v106
    v_dot2_f32_bf16 v107, v93, v197, v107
    v_dot2_f32_bf16 v108, v94, v192, v108
    v_dot2_f32_bf16 v109, v94, v197, v109
    v_dot2_f32_bf16 v110, v95, v192, v110
    v_dot2_f32_bf16 v111, v95, v197, v111
    s_waitcnt vmcnt(9)
    v_dot2_f32_bf16 v104, v224, v193, v104
    v_dot2_f32_bf16 v105, v224, v198, v105
    v_dot2_f32_bf16 v106, v225, v193, v106
    v_dot2_f32_bf16 v107, v225, v198, v107
    v_dot2_f32_bf16 v108, v226, v193, v108
    v_dot2_f32_bf16 v109, v226, v198, v109
    v_dot2_f32_bf16 v110, v227, v193, v110
    v_dot2_f32_bf16 v111, v227, v198, v111
    v_permlane32_swap_b32 v104, v108
    v_permlane32_swap_b32 v105, v109
    v_permlane32_swap_b32 v106, v110
    v_permlane32_swap_b32 v107, v111
    v_add_f32 v104, v104, v108
    v_add_f32 v105, v105, v109
    v_add_f32 v106, v106, v110
    v_add_f32 v107, v107, v111
    ds_write_b128 v248, v[104:107] offset:4096
    s_waitcnt lgkmcnt(0)
    s_barrier
    ds_read_b32 v96, v238 offset:0
    ds_read_b32 v97, v238 offset:1024
    ds_read_b32 v98, v238 offset:2048
    ds_read_b32 v99, v238 offset:3072
    ds_read_b32 v104, v238 offset:4096
    ds_read_b32 v105, v238 offset:5120
    ds_read_b32 v106, v238 offset:6144
    ds_read_b32 v107, v238 offset:7168
    s_waitcnt lgkmcnt(6)
    v_add_f32 v96, v96, v97
    s_waitcnt lgkmcnt(4)
    v_add_f32 v98, v98, v99
    v_mov_b32 v97, v2
    v_add_f32 v96, v96, v98
    buffer_store_dwordx2 v[96:97], v239, s[32:35], s58 offen sc1
    s_waitcnt lgkmcnt(2)
    v_add_f32 v104, v104, v105
    s_waitcnt lgkmcnt(0)
    v_add_f32 v106, v106, v107
    v_mov_b32 v105, v2
    v_add_f32 v104, v104, v106
    buffer_store_dwordx2 v[104:105], v240, s[32:35], s58 offen sc1
    s_lshl_b32 s51, s44, 4
    s_lshr_b64 s[14:15], s[14:15], s51
    s_and_b32 s14, s14, 0xffff
    v_and_b32 v251, 1, v252
    v_lshlrev_b32 v251, 4, v251
    v_lshlrev_b32_e64 v251, v251, s14
    v_lshrrev_b32 v248, 1, v252
    v_lshlrev_b32 v249, 2, v250
    v_sub_u32 v248, v248, v249
    v_cmp_eq_u32 vcc, -8, v248
    s_nop 1
    v_cndmask_b32 v44, 0, v251, vcc
    v_cmp_eq_u32 vcc, -7, v248
    s_nop 1
    v_cndmask_b32 v45, 0, v251, vcc
    v_cmp_eq_u32 vcc, -6, v248
    s_nop 1
    v_cndmask_b32 v46, 0, v251, vcc
    v_cmp_eq_u32 vcc, -5, v248
    s_nop 1
    v_cndmask_b32 v47, 0, v251, vcc
    s_mov_b32 s57, 22020096
    buffer_load_dword v36, v33, s[32:35], s57 offen sc1
    s_waitcnt vmcnt(11)
    v_alignbit_b32 v128, v55, v55, 16
    v_alignbit_b32 v129, v54, v54, 16
    v_alignbit_b32 v130, v53, v53, 16
    v_alignbit_b32 v131, v52, v52, 16
    ds_write_b128 v241, v[128:131] offset:3072
    v_bfi_b32 v132, s55, v55, v54
    v_bfi_b32 v133, s55, v54, v53
    v_bfi_b32 v134, s55, v53, v52
    s_waitcnt vmcnt(10)
    v_bfi_b32 v135, s55, v52, v69
    ds_write_b128 v241, v[132:135] offset:7232
    v_alignbit_b32 v136, v54, v54, 16
    v_alignbit_b32 v137, v53, v53, 16
    v_alignbit_b32 v138, v52, v52, 16
    v_alignbit_b32 v139, v69, v69, 16
    ds_write_b128 v241, v[136:139] offset:11392
    v_bfi_b32 v140, s55, v54, v53
    v_bfi_b32 v141, s55, v53, v52
    v_bfi_b32 v142, s55, v52, v69
    v_bfi_b32 v143, s55, v69, v68
    ds_write_b128 v241, v[140:143] offset:15552
    s_waitcnt vmcnt(9)
    v_alignbit_b32 v144, v59, v59, 16
    v_alignbit_b32 v145, v58, v58, 16
    v_alignbit_b32 v146, v57, v57, 16
    v_alignbit_b32 v147, v56, v56, 16
    ds_write_b128 v241, v[144:147] offset:2048
    v_bfi_b32 v148, s55, v59, v58
    v_bfi_b32 v149, s55, v58, v57
    v_bfi_b32 v150, s55, v57, v56
    s_waitcnt vmcnt(8)
    v_bfi_b32 v151, s55, v56, v71
    ds_write_b128 v241, v[148:151] offset:6208
    v_alignbit_b32 v152, v58, v58, 16
    v_alignbit_b32 v153, v57, v57, 16
    v_alignbit_b32 v154, v56, v56, 16
    v_alignbit_b32 v155, v71, v71, 16
    ds_write_b128 v241, v[152:155] offset:10368
    v_bfi_b32 v156, s55, v58, v57
    v_bfi_b32 v157, s55, v57, v56
    v_bfi_b32 v158, s55, v56, v71
    v_bfi_b32 v159, s55, v71, v70
    ds_write_b128 v241, v[156:159] offset:14528
    s_waitcnt vmcnt(0)
    v_cmp_ne_u32 vcc, v2, v36
    s_nop 1
    s_cbranch_vccnz Lspin1
Lback1:
    buffer_load_dwordx4 v4, s[32:35], s56 offen offset:0 sc1 lds
    buffer_load_dwordx4 v4, s[32:35], s56 offen offset:1024 sc1 lds
    buffer_load_dwordx4 v4, s[32:35], s56 offen offset:2048 sc1 lds
    buffer_load_dwordx4 v4, s[32:35], s56 offen offset:3072 sc1 lds
    s_mov_b32 s1, 22040576
    buffer_load_dword v37, v34, s[32:35], s1 offen sc1
    v_alignbit_b32 v128, v63, v63, 16
    v_alignbit_b32 v129, v62, v62, 16
    v_alignbit_b32 v130, v61, v61, 16
    v_alignbit_b32 v131, v60, v60, 16
    ds_write_b128 v241, v[128:131] offset:1024
    v_bfi_b32 v132, s55, v63, v62
    v_bfi_b32 v133, s55, v62, v61
    v_bfi_b32 v134, s55, v61, v60
    v_bfi_b32 v135, s55, v60, v73
    ds_write_b128 v241, v[132:135] offset:5184
    v_alignbit_b32 v136, v62, v62, 16
    v_alignbit_b32 v137, v61, v61, 16
    v_alignbit_b32 v138, v60, v60, 16
    v_alignbit_b32 v139, v73, v73, 16
    ds_write_b128 v241, v[136:139] offset:9344
    v_bfi_b32 v140, s55, v62, v61
    v_bfi_b32 v141, s55, v61, v60
    v_bfi_b32 v142, s55, v60, v73
    v_bfi_b32 v143, s55, v73, v72
    ds_write_b128 v241, v[140:143] offset:13504
    v_alignbit_b32 v144, v67, v67, 16
    v_alignbit_b32 v145, v66, v66, 16
    v_alignbit_b32 v146, v65, v65, 16
    v_alignbit_b32 v147, v64, v64, 16
    ds_write_b128 v241, v[144:147] offset:0
    v_bfi_b32 v148, s55, v67, v66
    v_bfi_b32 v149, s55, v66, v65
    v_bfi_b32 v150, s55, v65, v64
    v_bfi_b32 v151, s55, v64, v75
    ds_write_b128 v241, v[148:151] offset:4160
    v_alignbit_b32 v152, v66, v66, 16
    v_alignbit_b32 v153, v65, v65, 16
    v_alignbit_b32 v154, v64, v64, 16
    v_alignbit_b32 v155, v75, v75, 16
    ds_write_b128 v241, v[152:155] offset:8320
    v_bfi_b32 v156, s55, v66, v65
    v_bfi_b32 v157, s55, v65, v64
    v_bfi_b32 v158, s55, v64, v75
    v_bfi_b32 v159, s55, v75, v74
    ds_write_b128 v241, v[156:159] offset:12480
    buffer_load_dwordx4 v[40:43], v35, s[32:35], s58 offen sc1
    ds_read_b64 a[0:1], v28 offset:4032
    ds_read_b64 a[2:3], v28 offset:4040
    ds_read_b64 a[4:5], v28 offset:3520
    ds_read_b64 a[6:7], v28 offset:3528
    ds_read_b64 a[8:9], v28 offset:3008
    ds_read_b64 a[10:11], v28 offset:3016
    ds_read_b64 a[12:13], v28 offset:2496
    ds_read_b64 a[14:15], v28 offset:2504
    ds_read_b64 a[16:17], v28 offset:3968
    ds_read_b64 a[18:19], v28 offset:3976
    ds_read_b64 a[20:21], v28 offset:3456
    ds_read_b64 a[22:23], v28 offset:3464
    ds_read_b64 a[24:25], v28 offset:2944
    ds_read_b64 a[26:27], v28 offset:2952
    ds_read_b64 a[28:29], v28 offset:2432
    ds_read_b64 a[30:31], v28 offset:2440
    ds_read_b64 a[32:33], v28 offset:3904
    ds_read_b64 a[34:35], v28 offset:3912
    ds_read_b64 a[36:37], v28 offset:3392
    ds_read_b64 a[38:39], v28 offset:3400
    ds_read_b64 a[40:41], v28 offset:2880
    ds_read_b64 a[42:43], v28 offset:2888
    ds_read_b64 a[44:45], v28 offset:2368
    ds_read_b64 a[46:47], v28 offset:2376
    ds_read_b64 a[48:49], v28 offset:3840
    ds_read_b64 a[50:51], v28 offset:3848
    ds_read_b64 a[52:53], v28 offset:3328
    ds_read_b64 a[54:55], v28 offset:3336
    ds_read_b64 a[56:57], v28 offset:2816
    ds_read_b64 a[58:59], v28 offset:2824
    ds_read_b64 a[60:61], v28 offset:2304
    ds_read_b64 a[62:63], v28 offset:2312
    ds_read_b64 a[64:65], v28 offset:3776
    ds_read_b64 a[66:67], v28 offset:3784
    ds_read_b64 a[68:69], v28 offset:3264
    ds_read_b64 a[70:71], v28 offset:3272
    ds_read_b64 a[72:73], v28 offset:2752
    ds_read_b64 a[74:75], v28 offset:2760
    ds_read_b64 a[76:77], v28 offset:2240
    ds_read_b64 a[78:79], v28 offset:2248
    ds_read_b64 a[80:81], v28 offset:3712
    ds_read_b64 a[82:83], v28 offset:3720
    ds_read_b64 a[84:85], v28 offset:3200
    ds_read_b64 a[86:87], v28 offset:3208
    ds_read_b64 a[88:89], v28 offset:2688
    ds_read_b64 a[90:91], v28 offset:2696
    ds_read_b64 a[92:93], v28 offset:2176
    ds_read_b64 a[94:95], v28 offset:2184
    ds_read_b64 a[96:97], v28 offset:3648
    ds_read_b64 a[98:99], v28 offset:3656
    ds_read_b64 a[100:101], v28 offset:3136
    ds_read_b64 a[102:103], v28 offset:3144
    ds_read_b64 a[104:105], v28 offset:2624
    ds_read_b64 a[106:107], v28 offset:2632
    ds_read_b64 a[108:109], v28 offset:2112
    ds_read_b64 a[110:111], v28 offset:2120
    ds_read_b64 a[112:113], v28 offset:3584
    ds_read_b64 a[114:115], v28 offset:3592
    ds_read_b64 a[116:117], v28 offset:3072
    ds_read_b64 a[118:119], v28 offset:3080
    ds_read_b64 a[120:121], v28 offset:2560
    ds_read_b64 a[122:123], v28 offset:2568
    ds_read_b64 a[124:125], v28 offset:2048
    ds_read_b64 a[126:127], v28 offset:2056
    s_waitcnt vmcnt(1)
    v_cmp_ne_u32 vcc, v2, v37
    s_nop 1
    s_cbranch_vccnz Lspin2
Lback2:
    s_waitcnt vmcnt(0)
    v_cmp_ne_u32 vcc, v2, v41
    v_cmp_ne_u32 s[16:17], v2, v43
    s_nop 1
    s_or_b64 vcc, vcc, s[16:17]
    s_cbranch_vccnz Lspin3
Lback3:
    v_permlane16_swap_b32 v40, v42
    v_add_f32 v40, v40, v42
    s_nop 1
    v_add_f32_dpp v40, v40, v40 row_ror:8 row_mask:0xf bank_mask:0xf
    s_nop 1
    v_add_f32_dpp v40, v40, v40 row_ror:4 row_mask:0xf bank_mask:0xf
    s_nop 1
    v_add_f32_dpp v40, v40, v40 row_ror:2 row_mask:0xf bank_mask:0xf
    v_cvt_pk_bf16_f32 v40, v40, 0
    v_lshlrev_b32 v40, 16, v40
    v_mov_b32 v41, 109568
    ds_write_b32 v39, v40
    s_waitcnt lgkmcnt(0)
    s_barrier
    s_add_u32 s53, s52, 3670016
    buffer_load_dwordx4 v[208:211], v32, s[32:35], s53 offen sc1
    s_mov_b32 s53, 262144
    buffer_load_dwordx4 v[216:219], v32, s[32:35], s53 offen sc1
    s_add_u32 s53, s52, 3674112
    buffer_load_dwordx4 v[212:215], v32, s[32:35], s53 offen sc1
    s_mov_b32 s53, 266240
    buffer_load_dwordx4 v[220:223], v32, s[32:35], s53 offen sc1
    ds_read_b128 v[236:239], v41 offset:48
    ds_read_b128 v[228:231], v41 offset:16
    ds_read_b128 v[232:235], v41 offset:32
    ds_read_b128 v[224:227], v41 offset:0
    ds_read_b128 v[248:251], v41 offset:64
    ds_read_b128 v[252:255], v41 offset:80
    s_branch LS1
.p2align 12
LS1:
Lh0:
LhopC0:
    s_cbranch_execz Lh4
    ds_read_b128 v[80:83], v29 offset:480
    ds_read_b128 v[84:87], v29 offset:992
    ds_read_b128 v[88:91], v29 offset:1504
    ds_read_b128 v[92:95], v29 offset:2016
    s_waitcnt lgkmcnt(3)
    v_mfma_f32_16x16x32_bf16 v[48:51], v[44:47], v[80:83], 0
    ds_read_b128 v[112:115], v29 offset:416
    v_add_f32 v236, 1.0, v236
    v_mfma_f32_16x16x32_bf16 v[48:51], a[0:3], v[80:83], v[48:51]
    s_waitcnt lgkmcnt(3)
    ds_read_b128 v[116:119], v29 offset:928
    v_add_f32 v237, 1.0, v237
    v_mfma_f32_16x16x32_bf16 v[52:55], v[44:47], v[84:87], 0
    ds_read_b128 v[120:123], v29 offset:1440
    v_add_f32 v238, 1.0, v238
    v_mfma_f32_16x16x32_bf16 v[52:55], a[4:7], v[80:83], v[52:55]
    ds_read_b128 v[124:127], v29 offset:1952
    v_add_f32 v239, 1.0, v239
    v_mfma_f32_16x16x32_bf16 v[52:55], a[0:3], v[84:87], v[52:55]
    s_waitcnt lgkmcnt(5)
    v_cvt_pk_bf16_f32 v40, v236, v237
    v_cvt_pk_bf16_f32 v42, v238, v239
    v_mfma_f32_16x16x32_bf16 v[56:59], v[44:47], v[88:91], 0
    v_lshlrev_b32 v236, 16, v40
    v_and_b32 v237, 0xffff0000, v40
    v_mfma_f32_16x16x32_bf16 v[56:59], a[8:11], v[80:83], v[56:59]
    v_lshlrev_b32 v238, 16, v42
    v_and_b32 v239, 0xffff0000, v42
    v_mfma_f32_16x16x32_bf16 v[56:59], a[4:7], v[84:87], v[56:59]
    v_mov_b32 v43, 0x21800000
    v_cmp_eq_f32 s[4:5], 0, v236
    v_mfma_f32_16x16x32_bf16 v[56:59], a[0:3], v[88:91], v[56:59]
    s_waitcnt lgkmcnt(4)
    v_cmp_eq_f32 s[6:7], 0, v237
    v_cmp_eq_f32 s[8:9], 0, v238
    v_mfma_f32_16x16x32_bf16 v[60:63], v[44:47], v[92:95], 0
    v_cmp_eq_f32 s[10:11], 0, v239
    v_cndmask_b32 v24, v236, v43, s[4:5]
    v_mfma_f32_16x16x32_bf16 v[60:63], a[12:15], v[80:83], v[60:63]
Lh1:
LhopC1:
    s_cbranch_execz Lh5
    s_mov_b32 s97, 22061056
    v_cndmask_b32 v25, v237, v43, s[6:7]
    v_cndmask_b32 v26, v238, v43, s[8:9]
    v_mfma_f32_16x16x32_bf16 v[60:63], a[8:11], v[84:87], v[60:63]
    buffer_load_dword v38, v15, s[32:35], s97 offen sc1
    v_mfma_f32_16x16x32_bf16 v[60:63], a[4:7], v[88:91], v[60:63]
    v_cndmask_b32 v27, v239, v43, s[10:11]
    v_add_f32 v228, 1.0, v228
    v_mfma_f32_16x16x32_bf16 v[60:63], a[0:3], v[92:95], v[60:63]
    s_waitcnt lgkmcnt(3)
    v_add_f32 v229, 1.0, v229
    v_add_f32 v230, 1.0, v230
    v_mfma_f32_16x16x32_bf16 v[48:51], a[16:19], v[112:115], v[48:51]
    ds_read_b128 v[80:83], v29 offset:352
    v_add_f32 v231, 1.0, v231
    v_mfma_f32_16x16x32_bf16 v[52:55], a[20:23], v[112:115], v[52:55]
    s_waitcnt lgkmcnt(3)
    ds_read_b128 v[84:87], v29 offset:864
    v_cvt_pk_bf16_f32 v240, v228, v229
    v_mfma_f32_16x16x32_bf16 v[52:55], a[16:19], v[116:119], v[52:55]
    ds_read_b128 v[88:91], v29 offset:1376
    v_cvt_pk_bf16_f32 v241, v230, v231
    v_mfma_f32_16x16x32_bf16 v[56:59], a[24:27], v[112:115], v[56:59]
    ds_read_b128 v[92:95], v29 offset:1888
    v_lshlrev_b32 v228, 16, v240
    v_mfma_f32_16x16x32_bf16 v[56:59], a[20:23], v[116:119], v[56:59]
    s_waitcnt lgkmcnt(5)
    v_and_b32 v229, 0xffff0000, v240
    v_lshlrev_b32 v230, 16, v241
    v_mfma_f32_16x16x32_bf16 v[56:59], a[16:19], v[120:123], v[56:59]
    v_and_b32 v231, 0xffff0000, v241
    v_mul_f32 v232, v232, v24
    v_mfma_f32_16x16x32_bf16 v[60:63], a[28:31], v[112:115], v[60:63]
    v_mul_f32 v233, v233, v25
    v_mul_f32 v234, v234, v26
    v_mfma_f32_16x16x32_bf16 v[60:63], a[24:27], v[116:119], v[60:63]
Lh2:
LhopC2:
    s_cbranch_execz Lh6
    v_mul_f32 v235, v235, v27
    v_mul_f32 v240, v232, v228
    v_mfma_f32_16x16x32_bf16 v[60:63], a[20:23], v[120:123], v[60:63]
    s_waitcnt lgkmcnt(4)
    v_mul_f32 v241, v233, v229
    v_mul_f32 v242, v234, v230
    v_mfma_f32_16x16x32_bf16 v[60:63], a[16:19], v[124:127], v[60:63]
    s_waitcnt lgkmcnt(3)
    v_mul_f32 v243, v235, v231
    v_mul_f32 v244, v232, v224
    v_mfma_f32_16x16x32_bf16 v[48:51], a[32:35], v[80:83], v[48:51]
    ds_read_b128 v[112:115], v29 offset:288
    v_mul_f32 v245, v233, v225
    v_mfma_f32_16x16x32_bf16 v[52:55], a[36:39], v[80:83], v[52:55]
    s_waitcnt lgkmcnt(3)
    ds_read_b128 v[116:119], v29 offset:800
    v_mul_f32 v246, v234, v226
    v_mfma_f32_16x16x32_bf16 v[52:55], a[32:35], v[84:87], v[52:55]
    ds_read_b128 v[120:123], v29 offset:1312
    v_mul_f32 v247, v235, v227
    v_mfma_f32_16x16x32_bf16 v[56:59], a[40:43], v[80:83], v[56:59]
    ds_read_b128 v[124:127], v29 offset:1824
    v_rcp_f32 v236, v24
    v_mfma_f32_16x16x32_bf16 v[56:59], a[36:39], v[84:87], v[56:59]
    s_waitcnt lgkmcnt(5)
    v_rcp_f32 v237, v25
    v_mfma_f32_16x16x32_bf16 v[56:59], a[32:35], v[88:91], v[56:59]
    v_rcp_f32 v238, v26
    v_mfma_f32_16x16x32_bf16 v[60:63], a[44:47], v[80:83], v[60:63]
    v_rcp_f32 v239, v27
    v_mfma_f32_16x16x32_bf16 v[60:63], a[40:43], v[84:87], v[60:63]
    v_cvt_pk_bf16_f32 v248, v248, v249
    v_cvt_pk_bf16_f32 v250, v250, v251
    v_mfma_f32_16x16x32_bf16 v[60:63], a[36:39], v[88:91], v[60:63]
    s_waitcnt lgkmcnt(4)
    v_and_b32 v228, 1, v0
    v_cmp_eq_u32 s[4:5], 1, v228
    v_mfma_f32_16x16x32_bf16 v[60:63], a[32:35], v[92:95], v[60:63]
    s_waitcnt lgkmcnt(3)
    v_mov_b32 v41, v2
    v_mov_b32 v43, v2
    v_mfma_f32_16x16x32_bf16 v[48:51], a[48:51], v[112:115], v[48:51]
    ds_read_b128 v[80:83], v29 offset:224
    v_cndmask_b32 v40, v40, v248, s[4:5]
    v_mfma_f32_16x16x32_bf16 v[52:55], a[52:55], v[112:115], v[52:55]
    s_waitcnt lgkmcnt(3)
    ds_read_b128 v[84:87], v29 offset:736
    v_cndmask_b32 v42, v42, v250, s[4:5]
    v_mfma_f32_16x16x32_bf16 v[52:55], a[48:51], v[116:119], v[52:55]
    ds_read_b128 v[88:91], v29 offset:1248
    v_lshrrev_b32 v228, 3, v0
    v_mfma_f32_16x16x32_bf16 v[56:59], a[56:59], v[112:115], v[56:59]
    ds_read_b128 v[92:95], v29 offset:1760
    v_lshl_add_u32 v228, v228, 26, v32
    v_mfma_f32_16x16x32_bf16 v[56:59], a[52:55], v[116:119], v[56:59]
    s_waitcnt lgkmcnt(5)
    s_lshl_b32 s51, s45, 7
    s_add_u32 s51, s51, 434176
    v_mfma_f32_16x16x32_bf16 v[56:59], a[48:51], v[120:123], v[56:59]
    buffer_store_dwordx4 v[40:43], v228, s[32:35], s51 offen sc1
    v_mfma_f32_16x16x32_bf16 v[60:63], a[60:63], v[112:115], v[60:63]
    v_lshlrev_b32 v229, 24, v0
    v_lshl_or_b32 v229, v0, 31, v229
    v_mfma_f32_16x16x32_bf16 v[60:63], a[56:59], v[116:119], v[60:63]
    s_lshl_b32 s51, s45, 4
    s_add_u32 s51, s51, 425984
    v_mfma_f32_16x16x32_bf16 v[60:63], a[52:55], v[120:123], v[60:63]
    s_waitcnt lgkmcnt(4)
    buffer_store_dwordx4 v[236:239], v229, s[32:35], s51 offen sc1
    v_mfma_f32_16x16x32_bf16 v[60:63], a[48:51], v[124:127], v[60:63]
    s_waitcnt lgkmcnt(3)
    s_add_u32 s51, s51, 4096
    v_mfma_f32_16x16x32_bf16 v[48:51], a[64:67], v[80:83], v[48:51]
    buffer_store_dwordx4 v[252:255], v229, s[32:35], s51 offen sc1
    v_mfma_f32_16x16x32_bf16 v[52:55], a[68:71], v[80:83], v[52:55]
    s_waitcnt vmcnt(7) lgkmcnt(2)
    ds_read_b128 v[112:115], v29 offset:160
    v_lshlrev_b32 v176, 16, v208
    v_mfma_f32_16x16x32_bf16 v[52:55], a[64:67], v[84:87], v[52:55]
    ds_read_b128 v[116:119], v29 offset:672
    v_and_b32 v178, 0xffff0000, v208
    v_mfma_f32_16x16x32_bf16 v[56:59], a[72:75], v[80:83], v[56:59]
    ds_read_b128 v[120:123], v29 offset:1184
    v_lshlrev_b32 v180, 16, v209
    v_mfma_f32_16x16x32_bf16 v[56:59], a[68:71], v[84:87], v[56:59]
    s_waitcnt lgkmcnt(4)
    ds_read_b128 v[124:127], v29 offset:1696
    v_and_b32 v182, 0xffff0000, v209
    v_mfma_f32_16x16x32_bf16 v[56:59], a[64:67], v[88:91], v[56:59]
    s_waitcnt vmcnt(6)
    v_fma_f32 v192, v176, v216, v217
    v_fma_f32 v194, v178, v216, v217
    v_mfma_f32_16x16x32_bf16 v[60:63], a[76:79], v[80:83], v[60:63]
    s_waitcnt vmcnt(3)
    v_cmp_ne_u32 vcc, v2, v38
    s_nop 1
    s_cbranch_vccnz Lspin4
Lback4:
    v_mfma_f32_16x16x32_bf16 v[60:63], a[72:75], v[84:87], v[60:63]
    s_add_u32 s61, s60, 0
    v_fma_f32 v196, v180, v216, v217
    v_fma_f32 v198, v182, v216, v217
    v_mfma_f32_16x16x32_bf16 v[60:63], a[68:71], v[88:91], v[60:63]
    s_waitcnt lgkmcnt(4)
    buffer_load_dwordx4 a[128:131], v4, s[32:35], s61 offen offset:0 sc1
    v_mfma_f32_16x16x32_bf16 v[60:63], a[64:67], v[92:95], v[60:63]
    s_waitcnt lgkmcnt(3)
    buffer_load_dwordx4 a[132:135], v4, s[32:35], s61 offen offset:1024 sc1
    v_mfma_f32_16x16x32_bf16 v[48:51], a[80:83], v[112:115], v[48:51]
    ds_read_b128 v[80:83], v29 offset:96
    v_fma_f32 v192, v192, v240, v244
    v_mfma_f32_16x16x32_bf16 v[52:55], a[84:87], v[112:115], v[52:55]
    s_waitcnt lgkmcnt(3)
    buffer_load_dwordx4 a[136:139], v4, s[32:35], s61 offen offset:2048 sc1
    v_mfma_f32_16x16x32_bf16 v[52:55], a[80:83], v[116:119], v[52:55]
    ds_read_b128 v[84:87], v29 offset:608
    v_fma_f32 v194, v194, v241, v245
    v_mfma_f32_16x16x32_bf16 v[56:59], a[88:91], v[112:115], v[56:59]
    ds_read_b128 v[88:91], v29 offset:1120
    v_fma_f32 v196, v196, v242, v246
    v_mfma_f32_16x16x32_bf16 v[56:59], a[84:87], v[116:119], v[56:59]
    s_waitcnt lgkmcnt(4)
    buffer_load_dwordx4 a[140:143], v5, s[32:35], s61 offen offset:0 sc1
    v_mfma_f32_16x16x32_bf16 v[56:59], a[80:83], v[120:123], v[56:59]
    ds_read_b128 v[92:95], v29 offset:1632
    v_fma_f32 v198, v198, v243, v247
    v_mfma_f32_16x16x32_bf16 v[60:63], a[92:95], v[112:115], v[60:63]
    v_mul_f32 v176, v24, v176
    v_mul_f32 v178, v25, v178
    v_mfma_f32_16x16x32_bf16 v[60:63], a[88:91], v[116:119], v[60:63]
    v_mul_f32 v180, v26, v180
    v_mul_f32 v182, v27, v182
    v_mfma_f32_16x16x32_bf16 v[60:63], a[84:87], v[120:123], v[60:63]
    s_waitcnt lgkmcnt(4)
    buffer_load_dwordx4 a[144:147], v5, s[32:35], s61 offen offset:1024 sc1
    v_mfma_f32_16x16x32_bf16 v[60:63], a[80:83], v[124:127], v[60:63]
    s_waitcnt lgkmcnt(3)
    v_lshlrev_b32 v177, 16, v210
    v_and_b32 v179, 0xffff0000, v210
    v_mfma_f32_16x16x32_bf16 v[48:51], a[96:99], v[80:83], v[48:51]
    ds_read_b128 v[112:115], v29 offset:32
    v_lshlrev_b32 v181, 16, v211
    v_mfma_f32_16x16x32_bf16 v[52:55], a[100:103], v[80:83], v[52:55]
    s_waitcnt lgkmcnt(3)
    buffer_load_dwordx4 a[148:151], v5, s[32:35], s61 offen offset:2048 sc1
    v_mfma_f32_16x16x32_bf16 v[52:55], a[96:99], v[84:87], v[52:55]
    s_add_u32 s61, s60, 6144
    ds_read_b128 v[116:119], v29 offset:544
    v_and_b32 v183, 0xffff0000, v211
    v_mfma_f32_16x16x32_bf16 v[56:59], a[104:107], v[80:83], v[56:59]
    ds_read_b128 v[120:123], v29 offset:1056
    v_fma_f32 v193, v177, v218, v219
    v_mfma_f32_16x16x32_bf16 v[56:59], a[100:103], v[84:87], v[56:59]
    s_waitcnt lgkmcnt(4)
    ds_read_b128 v[124:127], v29 offset:1568
    v_fma_f32 v195, v179, v218, v219
    v_mfma_f32_16x16x32_bf16 v[56:59], a[96:99], v[88:91], v[56:59]
    buffer_load_dwordx4 a[152:155], v4, s[32:35], s61 offen offset:0 sc1
    v_mfma_f32_16x16x32_bf16 v[60:63], a[108:111], v[80:83], v[60:63]
    v_fma_f32 v197, v181, v218, v219
    v_fma_f32 v199, v183, v218, v219
    v_mfma_f32_16x16x32_bf16 v[60:63], a[104:107], v[84:87], v[60:63]
    v_fma_f32 v193, v193, v240, v244
    v_fma_f32 v195, v195, v241, v245
    v_mfma_f32_16x16x32_bf16 v[60:63], a[100:103], v[88:91], v[60:63]
    s_waitcnt lgkmcnt(4)
    v_fma_f32 v197, v197, v242, v246
    v_fma_f32 v199, v199, v243, v247
    v_mfma_f32_16x16x32_bf16 v[60:63], a[96:99], v[92:95], v[60:63]
    s_waitcnt lgkmcnt(3)
    buffer_load_dwordx4 a[156:159], v4, s[32:35], s61 offen offset:1024 sc1
    v_mfma_f32_16x16x32_bf16 v[48:51], a[112:115], v[112:115], v[48:51]
    ds_read_b128 v[80:83], v29 offset:480
    v_mul_f32 v177, v24, v177
    v_mfma_f32_16x16x32_bf16 v[52:55], a[116:119], v[112:115], v[52:55]
    s_waitcnt lgkmcnt(3)
    ds_read_b128 v[84:87], v29 offset:992
    v_mul_f32 v179, v25, v179
    v_mfma_f32_16x16x32_bf16 v[52:55], a[112:115], v[116:119], v[52:55]
    buffer_load_dwordx4 a[160:163], v4, s[32:35], s61 offen offset:2048 sc1
    v_mfma_f32_16x16x32_bf16 v[56:59], a[120:123], v[112:115], v[56:59]
    ds_read_b128 v[88:91], v29 offset:1504
    v_mul_f32 v181, v26, v181
    v_mfma_f32_16x16x32_bf16 v[56:59], a[116:119], v[116:119], v[56:59]
    s_waitcnt lgkmcnt(4)
    ds_read_b128 v[92:95], v29 offset:2016
    v_mul_f32 v183, v27, v183
    v_mfma_f32_16x16x32_bf16 v[56:59], a[112:115], v[120:123], v[56:59]
    ds_read_b128 v[96:99], v29 offset:2528
    ds_read_b128 v[100:103], v29 offset:3040
    v_mfma_f32_16x16x32_bf16 v[60:63], a[124:127], v[112:115], v[60:63]
    ds_read_b128 v[104:107], v29 offset:3552
    ds_read_b128 v[108:111], v29 offset:4064
    v_mfma_f32_16x16x32_bf16 v[60:63], a[120:123], v[116:119], v[60:63]
    buffer_load_dwordx4 a[164:167], v5, s[32:35], s61 offen offset:0 sc1
    v_mfma_f32_16x16x32_bf16 v[60:63], a[116:119], v[120:123], v[60:63]
    s_waitcnt lgkmcnt(8)
    v_lshlrev_b32 v184, 16, v212
    v_and_b32 v186, 0xffff0000, v212
    v_mfma_f32_16x16x32_bf16 v[60:63], a[112:115], v[124:127], v[60:63]
    buffer_load_dwordx4 a[168:171], v5, s[32:35], s61 offen offset:1024 sc1
    v_lshlrev_b32 v188, 16, v213
    v_and_b32 v190, 0xffff0000, v213
    v_fma_f32 v200, v184, v220, v221
    v_fma_f32 v202, v186, v220, v221
    v_fma_f32 v204, v188, v220, v221
    v_fma_f32 v206, v190, v220, v221
    v_fma_f32 v200, v200, v240, v244
    v_fma_f32 v202, v202, v241, v245
    v_fma_f32 v204, v204, v242, v246
    v_fma_f32 v206, v206, v243, v247
    v_mul_f32 v184, v24, v184
    v_mul_f32 v186, v25, v186
    v_mul_f32 v188, v26, v188
    v_mul_f32 v190, v27, v190
    v_lshlrev_b32 v185, 16, v214
    v_and_b32 v187, 0xffff0000, v214
    v_lshlrev_b32 v189, 16, v215
    v_and_b32 v191, 0xffff0000, v215
    v_fma_f32 v201, v185, v222, v223
    v_fma_f32 v203, v187, v222, v223
    v_fma_f32 v205, v189, v222, v223
    v_fma_f32 v207, v191, v222, v223
    v_fma_f32 v201, v201, v240, v244
    v_fma_f32 v203, v203, v241, v245
    v_fma_f32 v205, v205, v242, v246
    v_fma_f32 v207, v207, v243, v247
    v_mul_f32 v185, v24, v185
    v_mul_f32 v187, v25, v187
    v_mul_f32 v189, v26, v189
    v_mul_f32 v191, v27, v191
    ds_write_b128 v30, v[48:51] offset:0
    ds_write_b128 v30, v[52:55] offset:1024
    ds_write_b128 v30, v[56:59] offset:2048
    ds_write_b128 v30, v[60:63] offset:3072
    s_waitcnt lgkmcnt(0)
    s_barrier
    ds_read_b64 v[224:225], v31 offset:0
    ds_read_b64 v[226:227], v31 offset:4096
    ds_read_b64 v[228:229], v31 offset:8192
    ds_read_b64 v[230:231], v31 offset:12288
    ds_read_b64 v[232:233], v31 offset:2048
    ds_read_b64 v[234:235], v31 offset:6144
    ds_read_b64 v[236:237], v31 offset:10240
    ds_read_b64 v[238:239], v31 offset:14336
    s_waitcnt lgkmcnt(7)
    v_pk_fma_f32 v[224:225], v[192:193], v[224:225], v[176:177]
    s_waitcnt lgkmcnt(6)
    v_pk_fma_f32 v[226:227], v[194:195], v[226:227], v[178:179]
    s_waitcnt lgkmcnt(5)
    v_pk_fma_f32 v[228:229], v[196:197], v[228:229], v[180:181]
    s_waitcnt lgkmcnt(4)
    v_pk_fma_f32 v[230:231], v[198:199], v[230:231], v[182:183]
    v_cvt_pk_bf16_f32 v248, v224, v226
    v_cvt_pk_bf16_f32 v249, v228, v230
    v_cvt_pk_bf16_f32 v250, v225, v227
    v_cvt_pk_bf16_f32 v251, v229, v231
    s_add_u32 s53, s52, 6291456
    buffer_store_dwordx4 v[248:251], v32, s[32:35], s53 offen sc1
    s_waitcnt lgkmcnt(3)
    v_pk_fma_f32 v[232:233], v[200:201], v[232:233], v[184:185]
    s_waitcnt lgkmcnt(2)
    v_pk_fma_f32 v[234:235], v[202:203], v[234:235], v[186:187]
    s_waitcnt lgkmcnt(1)
    v_pk_fma_f32 v[236:237], v[204:205], v[236:237], v[188:189]
    s_waitcnt lgkmcnt(0)
    v_pk_fma_f32 v[238:239], v[206:207], v[238:239], v[190:191]
    v_cvt_pk_bf16_f32 v252, v232, v234
    v_cvt_pk_bf16_f32 v253, v236, v238
    v_cvt_pk_bf16_f32 v254, v233, v235
    v_cvt_pk_bf16_f32 v255, v237, v239
    s_add_u32 s53, s52, 6295552
    buffer_store_dwordx4 v[252:255], v32, s[32:35], s53 offen sc1
    ds_read_b64 v[144:145], v28 offset:1984
    ds_read_b64 v[146:147], v28 offset:1992
    ds_read_b64 v[148:149], v28 offset:1472
    ds_read_b64 v[150:151], v28 offset:1480
    ds_read_b64 v[152:153], v28 offset:960
    ds_read_b64 v[154:155], v28 offset:968
    ds_read_b64 v[156:157], v28 offset:448
    ds_read_b64 v[158:159], v28 offset:456
    v_mfma_f32_16x16x32_bf16 v[64:67], v[44:47], v[96:99], 0
    ds_read_b128 v[128:131], v29 offset:2464
    v_mfma_f32_16x16x32_bf16 v[64:67], a[0:3], v[96:99], v[64:67]
    ds_read_b128 v[124:127], v29 offset:1952
    v_mfma_f32_16x16x32_bf16 v[64:67], a[4:7], v[92:95], v[64:67]
    ds_read_b128 v[120:123], v29 offset:1440
    v_mfma_f32_16x16x32_bf16 v[64:67], a[8:11], v[88:91], v[64:67]
    ds_read_b128 v[116:119], v29 offset:928
    v_mfma_f32_16x16x32_bf16 v[64:67], a[12:15], v[84:87], v[64:67]
    s_waitcnt lgkmcnt(10)
    ds_read_b128 v[112:115], v29 offset:416
    v_mfma_f32_16x16x32_bf16 v[64:67], v[144:147], v[80:83], v[64:67]
    ds_read_b64 v[160:161], v28 offset:1920
    v_mfma_f32_16x16x32_bf16 v[68:71], v[44:47], v[100:103], 0
    ds_read_b64 v[162:163], v28 offset:1928
    v_mfma_f32_16x16x32_bf16 v[68:71], a[0:3], v[100:103], v[68:71]
    ds_read_b128 v[132:135], v29 offset:2976
    v_mfma_f32_16x16x32_bf16 v[68:71], a[4:7], v[96:99], v[68:71]
    ds_read_b64 v[164:165], v28 offset:1408
    v_mfma_f32_16x16x32_bf16 v[68:71], a[8:11], v[92:95], v[68:71]
    ds_read_b64 v[166:167], v28 offset:1416
    v_mfma_f32_16x16x32_bf16 v[68:71], a[12:15], v[88:91], v[68:71]
    ds_read_b128 v[136:139], v29 offset:3488
    v_mfma_f32_16x16x32_bf16 v[68:71], v[144:147], v[84:87], v[68:71]
    s_waitcnt lgkmcnt(15)
    ds_read_b64 v[168:169], v28 offset:896
    v_mfma_f32_16x16x32_bf16 v[68:71], v[148:151], v[80:83], v[68:71]
    ds_read_b64 v[170:171], v28 offset:904
    v_mfma_f32_16x16x32_bf16 v[72:75], v[44:47], v[104:107], 0
    ds_read_b128 v[140:143], v29 offset:4000
    v_mfma_f32_16x16x32_bf16 v[72:75], a[0:3], v[104:107], v[72:75]
    ds_read_b64 v[172:173], v28 offset:384
    v_mfma_f32_16x16x32_bf16 v[72:75], a[4:7], v[100:103], v[72:75]
    buffer_load_dwordx4 a[172:175], v5, s[32:35], s61 offen offset:2048 sc1
    v_mfma_f32_16x16x32_bf16 v[72:75], a[8:11], v[96:99], v[72:75]
    s_add_u32 s61, s60, 12288
    ds_read_b64 v[174:175], v28 offset:392
    v_mfma_f32_16x16x32_bf16 v[72:75], a[12:15], v[92:95], v[72:75]
    v_mfma_f32_16x16x32_bf16 v[72:75], v[144:147], v[88:91], v[72:75]
    v_mfma_f32_16x16x32_bf16 v[72:75], v[148:151], v[84:87], v[72:75]
    s_waitcnt lgkmcnt(15)
    buffer_load_dwordx4 a[176:179], v4, s[32:35], s61 offen offset:0 sc1
    v_mfma_f32_16x16x32_bf16 v[72:75], v[152:155], v[80:83], v[72:75]
    v_mfma_f32_16x16x32_bf16 v[76:79], v[44:47], v[108:111], 0
    v_mfma_f32_16x16x32_bf16 v[76:79], a[0:3], v[108:111], v[76:79]
    v_mfma_f32_16x16x32_bf16 v[76:79], a[4:7], v[104:107], v[76:79]
    buffer_load_dwordx4 a[180:183], v4, s[32:35], s61 offen offset:1024 sc1
    v_mfma_f32_16x16x32_bf16 v[76:79], a[8:11], v[100:103], v[76:79]
    v_mfma_f32_16x16x32_bf16 v[76:79], a[12:15], v[96:99], v[76:79]
    v_mfma_f32_16x16x32_bf16 v[76:79], v[144:147], v[92:95], v[76:79]
    buffer_load_dwordx4 a[184:187], v4, s[32:35], s61 offen offset:2048 sc1
    v_mfma_f32_16x16x32_bf16 v[76:79], v[148:151], v[88:91], v[76:79]
    v_mfma_f32_16x16x32_bf16 v[76:79], v[152:155], v[84:87], v[76:79]
    s_waitcnt lgkmcnt(15)
    v_mfma_f32_16x16x32_bf16 v[76:79], v[156:159], v[80:83], v[76:79]
    s_waitcnt lgkmcnt(15)
    v_mfma_f32_16x16x32_bf16 v[64:67], a[16:19], v[128:131], v[64:67]
    s_waitcnt lgkmcnt(14)
    buffer_load_dwordx4 a[188:191], v5, s[32:35], s61 offen offset:0 sc1
    v_mfma_f32_16x16x32_bf16 v[64:67], a[20:23], v[124:127], v[64:67]
    s_waitcnt lgkmcnt(13)
    ds_read_b128 v[96:99], v29 offset:2400
    v_mfma_f32_16x16x32_bf16 v[64:67], a[24:27], v[120:123], v[64:67]
    s_waitcnt lgkmcnt(13)
    ds_read_b128 v[92:95], v29 offset:1888
    v_mfma_f32_16x16x32_bf16 v[64:67], a[28:31], v[116:119], v[64:67]
    s_waitcnt lgkmcnt(11)
    ds_read_b128 v[88:91], v29 offset:1376
    v_mfma_f32_16x16x32_bf16 v[64:67], v[160:163], v[112:115], v[64:67]
    s_waitcnt lgkmcnt(11)
    buffer_load_dwordx4 a[192:195], v5, s[32:35], s61 offen offset:1024 sc1
    v_mfma_f32_16x16x32_bf16 v[68:71], a[16:19], v[132:135], v[68:71]
    ds_read_b128 v[84:87], v29 offset:864
    v_mfma_f32_16x16x32_bf16 v[68:71], a[20:23], v[128:131], v[68:71]
    ds_read_b128 v[80:83], v29 offset:352
    v_mfma_f32_16x16x32_bf16 v[68:71], a[24:27], v[124:127], v[68:71]
    buffer_load_dwordx4 a[196:199], v5, s[32:35], s61 offen offset:2048 sc1
    v_mfma_f32_16x16x32_bf16 v[68:71], a[28:31], v[120:123], v[68:71]
    s_add_u32 s61, s60, 18432
    ds_read_b64 v[144:145], v28 offset:1856
    v_mfma_f32_16x16x32_bf16 v[68:71], v[160:163], v[116:119], v[68:71]
    s_waitcnt lgkmcnt(12)
    ds_read_b64 v[146:147], v28 offset:1864
    v_mfma_f32_16x16x32_bf16 v[68:71], v[164:167], v[112:115], v[68:71]
    s_waitcnt lgkmcnt(12)
    ds_read_b128 v[100:103], v29 offset:2912
    v_mfma_f32_16x16x32_bf16 v[72:75], a[16:19], v[136:139], v[72:75]
    buffer_load_dwordx4 a[200:203], v4, s[32:35], s61 offen offset:0 sc1
    v_mfma_f32_16x16x32_bf16 v[72:75], a[20:23], v[132:135], v[72:75]
    ds_read_b64 v[148:149], v28 offset:1344
    v_mfma_f32_16x16x32_bf16 v[72:75], a[24:27], v[128:131], v[72:75]
    ds_read_b64 v[150:151], v28 offset:1352
    v_mfma_f32_16x16x32_bf16 v[72:75], a[28:31], v[124:127], v[72:75]
    buffer_load_dwordx4 a[204:207], v4, s[32:35], s61 offen offset:1024 sc1
    v_mfma_f32_16x16x32_bf16 v[72:75], v[160:163], v[120:123], v[72:75]
    ds_read_b128 v[104:107], v29 offset:3424
    v_mfma_f32_16x16x32_bf16 v[72:75], v[164:167], v[116:119], v[72:75]
    s_waitcnt lgkmcnt(14)
    ds_read_b64 v[152:153], v28 offset:832
    v_mfma_f32_16x16x32_bf16 v[72:75], v[168:171], v[112:115], v[72:75]
    s_waitcnt lgkmcnt(14)
    ds_read_b64 v[154:155], v28 offset:840
    v_mfma_f32_16x16x32_bf16 v[76:79], a[16:19], v[140:143], v[76:79]
    s_waitcnt vmcnt(9)
    s_barrier
    ds_read_b128 v[108:111], v29 offset:3936
    v_mfma_f32_16x16x32_bf16 v[76:79], a[20:23], v[136:139], v[76:79]
    s_lshl_b32 s51, s45, 7
    ds_read_b64 v[156:157], v28 offset:320
    ds_read_b64 v[158:159], v28 offset:328
    v_mfma_f32_16x16x32_bf16 v[76:79], a[24:27], v[132:135], v[76:79]
    s_add_u32 s51, s51, 22085632
    v_mfma_f32_16x16x32_bf16 v[76:79], a[28:31], v[128:131], v[76:79]
    buffer_store_dword v2, v3, s[32:35], s51 offen sc1
    v_mfma_f32_16x16x32_bf16 v[76:79], v[160:163], v[124:127], v[76:79]
    buffer_load_dwordx4 a[208:211], v4, s[32:35], s61 offen offset:2048 sc1
    v_mfma_f32_16x16x32_bf16 v[76:79], v[164:167], v[120:123], v[76:79]
    buffer_load_dwordx4 a[212:215], v5, s[32:35], s61 offen offset:0 sc1
    v_mfma_f32_16x16x32_bf16 v[76:79], v[168:171], v[116:119], v[76:79]
    s_waitcnt lgkmcnt(15)
    v_lshrrev_b32 v34, 3, v0
    v_lshlrev_b32 v34, 7, v34
    v_mfma_f32_16x16x32_bf16 v[76:79], v[172:175], v[112:115], v[76:79]
    s_waitcnt lgkmcnt(15)
    v_mfma_f32_16x16x32_bf16 v[64:67], a[32:35], v[96:99], v[64:67]
    s_waitcnt lgkmcnt(14)
    ds_read_b128 v[128:131], v29 offset:2336
    v_mfma_f32_16x16x32_bf16 v[64:67], a[36:39], v[92:95], v[64:67]
    s_waitcnt lgkmcnt(14)
    buffer_load_dwordx4 a[216:219], v5, s[32:35], s61 offen offset:1024 sc1
    v_mfma_f32_16x16x32_bf16 v[64:67], a[40:43], v[88:91], v[64:67]
    s_waitcnt lgkmcnt(13)
    ds_read_b128 v[124:127], v29 offset:1824
    v_mfma_f32_16x16x32_bf16 v[64:67], a[44:47], v[84:87], v[64:67]
    s_waitcnt lgkmcnt(11)
    ds_read_b128 v[120:123], v29 offset:1312
    v_mfma_f32_16x16x32_bf16 v[64:67], v[144:147], v[80:83], v[64:67]
    s_waitcnt lgkmcnt(11)
    ds_read_b128 v[116:119], v29 offset:800
    v_mfma_f32_16x16x32_bf16 v[68:71], a[32:35], v[100:103], v[68:71]
    buffer_load_dwordx4 a[220:223], v5, s[32:35], s61 offen offset:2048 sc1
    v_mfma_f32_16x16x32_bf16 v[68:71], a[36:39], v[96:99], v[68:71]
    s_add_u32 s61, s60, 24576
    ds_read_b128 v[112:115], v29 offset:288
    v_mfma_f32_16x16x32_bf16 v[68:71], a[40:43], v[92:95], v[68:71]
    ds_read_b64 v[160:161], v28 offset:1792
    v_mfma_f32_16x16x32_bf16 v[68:71], a[44:47], v[88:91], v[68:71]
    buffer_load_dwordx4 a[224:227], v4, s[32:35], s61 offen offset:0 sc1
    v_mfma_f32_16x16x32_bf16 v[68:71], v[144:147], v[84:87], v[68:71]
    s_waitcnt lgkmcnt(12)
    ds_read_b64 v[162:163], v28 offset:1800
    v_mfma_f32_16x16x32_bf16 v[68:71], v[148:151], v[80:83], v[68:71]
    s_waitcnt lgkmcnt(12)
    ds_read_b128 v[132:135], v29 offset:2848
    v_mfma_f32_16x16x32_bf16 v[72:75], a[32:35], v[104:107], v[72:75]
    ds_read_b64 v[164:165], v28 offset:1280
    v_mfma_f32_16x16x32_bf16 v[72:75], a[36:39], v[100:103], v[72:75]
    buffer_load_dwordx4 a[228:231], v4, s[32:35], s61 offen offset:1024 sc1
    v_mfma_f32_16x16x32_bf16 v[72:75], a[40:43], v[96:99], v[72:75]
    ds_read_b64 v[166:167], v28 offset:1288
    v_mfma_f32_16x16x32_bf16 v[72:75], a[44:47], v[92:95], v[72:75]
    ds_read_b128 v[136:139], v29 offset:3360
    v_mfma_f32_16x16x32_bf16 v[72:75], v[144:147], v[88:91], v[72:75]
    buffer_load_dwordx4 a[232:235], v4, s[32:35], s61 offen offset:2048 sc1
    v_mfma_f32_16x16x32_bf16 v[72:75], v[148:151], v[84:87], v[72:75]
    s_waitcnt lgkmcnt(14)
    ds_read_b64 v[168:169], v28 offset:768
    v_mfma_f32_16x16x32_bf16 v[72:75], v[152:155], v[80:83], v[72:75]
    s_waitcnt lgkmcnt(14)
    ds_read_b64 v[170:171], v28 offset:776
    v_mfma_f32_16x16x32_bf16 v[76:79], a[32:35], v[108:111], v[76:79]
    ds_read_b128 v[140:143], v29 offset:3872
    v_mfma_f32_16x16x32_bf16 v[76:79], a[36:39], v[104:107], v[76:79]
    s_mov_b32 s57, 22048768
    ds_read_b64 v[172:173], v28 offset:256
    ds_read_b64 v[174:175], v28 offset:264
    v_mfma_f32_16x16x32_bf16 v[76:79], a[40:43], v[100:103], v[76:79]
    buffer_load_dword v36, v34, s[32:35], s57 offen sc1
    v_mfma_f32_16x16x32_bf16 v[76:79], a[44:47], v[96:99], v[76:79]
    v_mfma_f32_16x16x32_bf16 v[76:79], v[144:147], v[92:95], v[76:79]
    buffer_load_dwordx4 a[236:239], v5, s[32:35], s61 offen offset:0 sc1
    v_mfma_f32_16x16x32_bf16 v[76:79], v[148:151], v[88:91], v[76:79]
    v_mfma_f32_16x16x32_bf16 v[76:79], v[152:155], v[84:87], v[76:79]
    s_waitcnt lgkmcnt(15)
    v_mfma_f32_16x16x32_bf16 v[76:79], v[156:159], v[80:83], v[76:79]
    s_waitcnt lgkmcnt(15)
    v_mfma_f32_16x16x32_bf16 v[64:67], a[48:51], v[128:131], v[64:67]
    s_waitcnt lgkmcnt(14)
    buffer_load_dwordx4 a[0:3], v5, s[32:35], s61 offen offset:1024 sc1
    v_mfma_f32_16x16x32_bf16 v[64:67], a[52:55], v[124:127], v[64:67]
    s_waitcnt lgkmcnt(13)
    ds_read_b128 v[96:99], v29 offset:2272
    v_mfma_f32_16x16x32_bf16 v[64:67], a[56:59], v[120:123], v[64:67]
    s_waitcnt lgkmcnt(13)
    ds_read_b128 v[92:95], v29 offset:1760
    v_mfma_f32_16x16x32_bf16 v[64:67], a[60:63], v[116:119], v[64:67]
    s_waitcnt lgkmcnt(11)
    ds_read_b128 v[88:91], v29 offset:1248
    v_mfma_f32_16x16x32_bf16 v[64:67], v[160:163], v[112:115], v[64:67]
    s_waitcnt lgkmcnt(11)
    buffer_load_dwordx4 a[4:7], v5, s[32:35], s61 offen offset:2048 sc1
    v_mfma_f32_16x16x32_bf16 v[68:71], a[48:51], v[132:135], v[68:71]
    s_add_u32 s61, s60, 30720
    ds_read_b128 v[84:87], v29 offset:736
    v_mfma_f32_16x16x32_bf16 v[68:71], a[52:55], v[128:131], v[68:71]
    ds_read_b128 v[80:83], v29 offset:224
    v_mfma_f32_16x16x32_bf16 v[68:71], a[56:59], v[124:127], v[68:71]
    buffer_load_dwordx4 a[8:11], v4, s[32:35], s61 offen offset:0 sc1
    v_mfma_f32_16x16x32_bf16 v[68:71], a[60:63], v[120:123], v[68:71]
    ds_read_b64 v[144:145], v28 offset:1728
    v_mfma_f32_16x16x32_bf16 v[68:71], v[160:163], v[116:119], v[68:71]
    s_waitcnt lgkmcnt(12)
    ds_read_b64 v[146:147], v28 offset:1736
    v_mfma_f32_16x16x32_bf16 v[68:71], v[164:167], v[112:115], v[68:71]
    s_waitcnt lgkmcnt(12)
    ds_read_b128 v[100:103], v29 offset:2784
    v_mfma_f32_16x16x32_bf16 v[72:75], a[48:51], v[136:139], v[72:75]
    buffer_load_dwordx4 a[12:15], v4, s[32:35], s61 offen offset:1024 sc1
    v_mfma_f32_16x16x32_bf16 v[72:75], a[52:55], v[132:135], v[72:75]
    ds_read_b64 v[148:149], v28 offset:1216
    v_mfma_f32_16x16x32_bf16 v[72:75], a[56:59], v[128:131], v[72:75]
    ds_read_b64 v[150:151], v28 offset:1224
    v_mfma_f32_16x16x32_bf16 v[72:75], a[60:63], v[124:127], v[72:75]
    buffer_load_dwordx4 a[16:19], v4, s[32:35], s61 offen offset:2048 sc1
    v_mfma_f32_16x16x32_bf16 v[72:75], v[160:163], v[120:123], v[72:75]
    ds_read_b128 v[104:107], v29 offset:3296
    v_mfma_f32_16x16x32_bf16 v[72:75], v[164:167], v[116:119], v[72:75]
    s_waitcnt lgkmcnt(14)
    ds_read_b64 v[152:153], v28 offset:704
    v_mfma_f32_16x16x32_bf16 v[72:75], v[168:171], v[112:115], v[72:75]
Lh3:
LhopC3:
    s_cbranch_execz Lh7
    s_waitcnt lgkmcnt(14)
    ds_read_b64 v[154:155], v28 offset:712
    v_mfma_f32_16x16x32_bf16 v[76:79], a[48:51], v[140:143], v[76:79]
    buffer_load_dwordx4 a[20:23], v5, s[32:35], s61 offen offset:0 sc1
    v_mfma_f32_16x16x32_bf16 v[76:79], a[52:55], v[136:139], v[76:79]
    ds_read_b128 v[108:111], v29 offset:3808
    ds_read_b64 v[156:157], v28 offset:192
    v_mfma_f32_16x16x32_bf16 v[76:79], a[56:59], v[132:135], v[76:79]
    ds_read_b64 v[158:159], v28 offset:200
    v_mfma_f32_16x16x32_bf16 v[76:79], a[60:63], v[128:131], v[76:79]
    v_mfma_f32_16x16x32_bf16 v[76:79], v[160:163], v[124:127], v[76:79]
    buffer_load_dwordx4 a[24:27], v5, s[32:35], s61 offen offset:1024 sc1
    v_mfma_f32_16x16x32_bf16 v[76:79], v[164:167], v[120:123], v[76:79]
    v_mfma_f32_16x16x32_bf16 v[76:79], v[168:171], v[116:119], v[76:79]
    s_waitcnt lgkmcnt(15)
    v_mfma_f32_16x16x32_bf16 v[76:79], v[172:175], v[112:115], v[76:79]
    s_waitcnt lgkmcnt(15)
    buffer_load_dwordx4 a[28:31], v5, s[32:35], s61 offen offset:2048 sc1
    v_mfma_f32_16x16x32_bf16 v[64:67], a[64:67], v[96:99], v[64:67]
    s_waitcnt lgkmcnt(14)
    s_add_u32 s61, s60, 36864
    ds_read_b128 v[128:131], v29 offset:2208
    v_mfma_f32_16x16x32_bf16 v[64:67], a[68:71], v[92:95], v[64:67]
    s_waitcnt lgkmcnt(14)
    ds_read_b128 v[124:127], v29 offset:1696
    v_mfma_f32_16x16x32_bf16 v[64:67], a[72:75], v[88:91], v[64:67]
    s_waitcnt lgkmcnt(14)
    ds_read_b128 v[120:123], v29 offset:1184
    v_mfma_f32_16x16x32_bf16 v[64:67], a[76:79], v[84:87], v[64:67]
    s_waitcnt lgkmcnt(12)
    buffer_load_dwordx4 a[32:35], v4, s[32:35], s61 offen offset:0 sc1
    v_mfma_f32_16x16x32_bf16 v[64:67], v[144:147], v[80:83], v[64:67]
    s_waitcnt lgkmcnt(11)
    ds_read_b128 v[116:119], v29 offset:672
    v_mfma_f32_16x16x32_bf16 v[68:71], a[64:67], v[100:103], v[68:71]
Lh4:
    s_cbranch_execz Lh8
    ds_read_b128 v[112:115], v29 offset:160
    v_mfma_f32_16x16x32_bf16 v[68:71], a[68:71], v[96:99], v[68:71]
    buffer_load_dwordx4 a[36:39], v4, s[32:35], s61 offen offset:1024 sc1
    v_mfma_f32_16x16x32_bf16 v[68:71], a[72:75], v[92:95], v[68:71]
    s_waitcnt vmcnt(11)
    ds_read_b64 v[160:161], v28 offset:1664
    v_cmp_ne_u32 vcc, v2, v36
    s_nop 1
    s_cbranch_vccnz Lspin6
Lback6:
    v_mfma_f32_16x16x32_bf16 v[68:71], a[76:79], v[88:91], v[68:71]
    s_barrier
    ds_read_b64 v[162:163], v28 offset:1672
    s_add_u32 s53, s52, 3678208
    v_mfma_f32_16x16x32_bf16 v[68:71], v[144:147], v[84:87], v[68:71]
    s_waitcnt lgkmcnt(13)
    ds_read_b128 v[132:135], v29 offset:2720
    v_mfma_f32_16x16x32_bf16 v[68:71], v[148:151], v[80:83], v[68:71]
    s_waitcnt lgkmcnt(13)
    buffer_load_dwordx4 v[208:211], v32, s[32:35], s53 offen sc1
    v_mfma_f32_16x16x32_bf16 v[72:75], a[64:67], v[104:107], v[72:75]
    s_mov_b32 s53, 270336
    ds_read_b64 v[164:165], v28 offset:1152
    v_mfma_f32_16x16x32_bf16 v[72:75], a[68:71], v[100:103], v[72:75]
    ds_read_b64 v[166:167], v28 offset:1160
    v_mfma_f32_16x16x32_bf16 v[72:75], a[72:75], v[96:99], v[72:75]
    ds_read_b128 v[136:139], v29 offset:3232
    v_mfma_f32_16x16x32_bf16 v[72:75], a[76:79], v[92:95], v[72:75]
    buffer_load_dwordx4 v[216:219], v32, s[32:35], s53 offen sc1
    v_mfma_f32_16x16x32_bf16 v[72:75], v[144:147], v[88:91], v[72:75]
    s_add_u32 s53, s52, 3682304
    ds_read_b64 v[168:169], v28 offset:640
    v_mfma_f32_16x16x32_bf16 v[72:75], v[148:151], v[84:87], v[72:75]
    s_waitcnt lgkmcnt(15)
    ds_read_b64 v[170:171], v28 offset:648
    v_mfma_f32_16x16x32_bf16 v[72:75], v[152:155], v[80:83], v[72:75]
Lh5:
    s_cbranch_execz Lh9
    s_waitcnt lgkmcnt(15)
    buffer_load_dwordx4 v[212:215], v32, s[32:35], s53 offen sc1
    v_mfma_f32_16x16x32_bf16 v[76:79], a[64:67], v[108:111], v[76:79]
    s_mov_b32 s53, 274432
    ds_read_b128 v[140:143], v29 offset:3744
    v_mfma_f32_16x16x32_bf16 v[76:79], a[68:71], v[104:107], v[76:79]
    ds_read_b64 v[172:173], v28 offset:128
    ds_read_b64 v[174:175], v28 offset:136
    v_mfma_f32_16x16x32_bf16 v[76:79], a[72:75], v[100:103], v[76:79]
    v_mfma_f32_16x16x32_bf16 v[76:79], a[76:79], v[96:99], v[76:79]
    buffer_load_dwordx4 v[220:223], v32, s[32:35], s53 offen sc1
    v_mfma_f32_16x16x32_bf16 v[76:79], v[144:147], v[92:95], v[76:79]
    v_mfma_f32_16x16x32_bf16 v[76:79], v[148:151], v[88:91], v[76:79]
    v_mfma_f32_16x16x32_bf16 v[76:79], v[152:155], v[84:87], v[76:79]
    s_waitcnt lgkmcnt(15)
    buffer_load_dwordx4 a[40:43], v4, s[32:35], s61 offen offset:2048 sc1
    v_mfma_f32_16x16x32_bf16 v[76:79], v[156:159], v[80:83], v[76:79]
    s_waitcnt lgkmcnt(15)
    v_mfma_f32_16x16x32_bf16 v[64:67], a[80:83], v[128:131], v[64:67]
    s_waitcnt lgkmcnt(14)
    ds_read_b128 v[96:99], v29 offset:2144
    v_mfma_f32_16x16x32_bf16 v[64:67], a[84:87], v[124:127], v[64:67]
    s_waitcnt lgkmcnt(14)
    ds_read_b128 v[92:95], v29 offset:1632
    v_mfma_f32_16x16x32_bf16 v[64:67], a[88:91], v[120:123], v[64:67]
    s_waitcnt lgkmcnt(14)
    buffer_load_dwordx4 a[44:47], v5, s[32:35], s61 offen offset:0 sc1
    v_mfma_f32_16x16x32_bf16 v[64:67], a[92:95], v[116:119], v[64:67]
    s_waitcnt lgkmcnt(11)
    ds_read_b128 v[88:91], v29 offset:1120
    v_mfma_f32_16x16x32_bf16 v[64:67], v[160:163], v[112:115], v[64:67]
    s_waitcnt lgkmcnt(11)
    ds_read_b128 v[84:87], v29 offset:608
    v_mfma_f32_16x16x32_bf16 v[68:71], a[80:83], v[132:135], v[68:71]
    ds_read_b128 v[80:83], v29 offset:96
    v_mfma_f32_16x16x32_bf16 v[68:71], a[84:87], v[128:131], v[68:71]
    buffer_load_dwordx4 a[48:51], v5, s[32:35], s61 offen offset:1024 sc1
    v_mfma_f32_16x16x32_bf16 v[68:71], a[88:91], v[124:127], v[68:71]
    ds_read_b64 v[144:145], v28 offset:1600
    v_mfma_f32_16x16x32_bf16 v[68:71], a[92:95], v[120:123], v[68:71]
    ds_read_b64 v[146:147], v28 offset:1608
    v_mfma_f32_16x16x32_bf16 v[68:71], v[160:163], v[116:119], v[68:71]
    s_waitcnt lgkmcnt(13)
    buffer_load_dwordx4 a[52:55], v5, s[32:35], s61 offen offset:2048 sc1
    v_mfma_f32_16x16x32_bf16 v[68:71], v[164:167], v[112:115], v[68:71]
    s_waitcnt lgkmcnt(12)
    s_add_u32 s61, s60, 43008
    ds_read_b128 v[100:103], v29 offset:2656
    v_mfma_f32_16x16x32_bf16 v[72:75], a[80:83], v[136:139], v[72:75]
    ds_read_b64 v[148:149], v28 offset:1088
    v_mfma_f32_16x16x32_bf16 v[72:75], a[84:87], v[132:135], v[72:75]
    ds_read_b64 v[150:151], v28 offset:1096
    v_mfma_f32_16x16x32_bf16 v[72:75], a[88:91], v[128:131], v[72:75]
    buffer_load_dwordx4 a[56:59], v4, s[32:35], s61 offen offset:0 sc1
    v_mfma_f32_16x16x32_bf16 v[72:75], a[92:95], v[124:127], v[72:75]
    ds_read_b128 v[104:107], v29 offset:3168
    v_mfma_f32_16x16x32_bf16 v[72:75], v[160:163], v[120:123], v[72:75]
    ds_read_b64 v[152:153], v28 offset:576
    v_mfma_f32_16x16x32_bf16 v[72:75], v[164:167], v[116:119], v[72:75]
    s_waitcnt lgkmcnt(15)
    buffer_load_dwordx4 a[60:63], v4, s[32:35], s61 offen offset:1024 sc1
    v_mfma_f32_16x16x32_bf16 v[72:75], v[168:171], v[112:115], v[72:75]
    s_waitcnt lgkmcnt(14)
    ds_read_b64 v[154:155], v28 offset:584
    v_mfma_f32_16x16x32_bf16 v[76:79], a[80:83], v[140:143], v[76:79]
    ds_read_b128 v[108:111], v29 offset:3680
    v_mfma_f32_16x16x32_bf16 v[76:79], a[84:87], v[136:139], v[76:79]
    ds_read_b64 v[156:157], v28 offset:64
    ds_read_b64 v[158:159], v28 offset:72
    v_mfma_f32_16x16x32_bf16 v[76:79], a[88:91], v[132:135], v[76:79]
    buffer_load_dwordx4 a[64:67], v4, s[32:35], s61 offen offset:2048 sc1
    v_mfma_f32_16x16x32_bf16 v[76:79], a[92:95], v[128:131], v[76:79]
    v_mfma_f32_16x16x32_bf16 v[76:79], v[160:163], v[124:127], v[76:79]
    v_mfma_f32_16x16x32_bf16 v[76:79], v[164:167], v[120:123], v[76:79]
    v_mfma_f32_16x16x32_bf16 v[76:79], v[168:171], v[116:119], v[76:79]
    s_waitcnt lgkmcnt(15)
    buffer_load_dwordx4 a[68:71], v5, s[32:35], s61 offen offset:0 sc1
    v_mfma_f32_16x16x32_bf16 v[76:79], v[172:175], v[112:115], v[76:79]
    s_waitcnt lgkmcnt(15)
    v_mfma_f32_16x16x32_bf16 v[64:67], a[96:99], v[96:99], v[64:67]
    s_waitcnt lgkmcnt(14)
    ds_read_b128 v[128:131], v29 offset:2080
    v_mfma_f32_16x16x32_bf16 v[64:67], a[100:103], v[92:95], v[64:67]
    s_waitcnt lgkmcnt(14)
    buffer_load_dwordx4 a[72:75], v5, s[32:35], s61 offen offset:1024 sc1
    v_mfma_f32_16x16x32_bf16 v[64:67], a[104:107], v[88:91], v[64:67]
    s_waitcnt lgkmcnt(13)
    ds_read_b128 v[124:127], v29 offset:1568
    v_mfma_f32_16x16x32_bf16 v[64:67], a[108:111], v[84:87], v[64:67]
    s_waitcnt lgkmcnt(11)
    ds_read_b128 v[120:123], v29 offset:1056
    v_mfma_f32_16x16x32_bf16 v[64:67], v[144:147], v[80:83], v[64:67]
    s_waitcnt lgkmcnt(11)
    ds_read_b128 v[116:119], v29 offset:544
    v_mfma_f32_16x16x32_bf16 v[68:71], a[96:99], v[100:103], v[68:71]
    buffer_load_dwordx4 a[76:79], v5, s[32:35], s61 offen offset:2048 sc1
    v_mfma_f32_16x16x32_bf16 v[68:71], a[100:103], v[96:99], v[68:71]
    s_add_u32 s61, s60, 49152
    ds_read_b128 v[112:115], v29 offset:32
    v_mfma_f32_16x16x32_bf16 v[68:71], a[104:107], v[92:95], v[68:71]
    ds_read_b64 v[160:161], v28 offset:1536
    v_mfma_f32_16x16x32_bf16 v[68:71], a[108:111], v[88:91], v[68:71]
    buffer_load_dwordx4 a[80:83], v4, s[32:35], s61 offen offset:0 sc1
    v_mfma_f32_16x16x32_bf16 v[68:71], v[144:147], v[84:87], v[68:71]
    s_waitcnt lgkmcnt(12)
    ds_read_b64 v[162:163], v28 offset:1544
    v_mfma_f32_16x16x32_bf16 v[68:71], v[148:151], v[80:83], v[68:71]
    s_waitcnt lgkmcnt(12)
    ds_read_b128 v[132:135], v29 offset:2592
    v_mfma_f32_16x16x32_bf16 v[72:75], a[96:99], v[104:107], v[72:75]
    ds_read_b64 v[164:165], v28 offset:1024
    v_mfma_f32_16x16x32_bf16 v[72:75], a[100:103], v[100:103], v[72:75]
    buffer_load_dwordx4 a[84:87], v4, s[32:35], s61 offen offset:1024 sc1
    v_mfma_f32_16x16x32_bf16 v[72:75], a[104:107], v[96:99], v[72:75]
    ds_read_b64 v[166:167], v28 offset:1032
    v_mfma_f32_16x16x32_bf16 v[72:75], a[108:111], v[92:95], v[72:75]
    ds_read_b128 v[136:139], v29 offset:3104
    v_mfma_f32_16x16x32_bf16 v[72:75], v[144:147], v[88:91], v[72:75]
    ds_read_b64 v[168:169], v28 offset:512
    v_mfma_f32_16x16x32_bf16 v[72:75], v[148:151], v[84:87], v[72:75]
    s_waitcnt lgkmcnt(15)
    buffer_load_dwordx4 a[88:91], v4, s[32:35], s61 offen offset:2048 sc1
    v_mfma_f32_16x16x32_bf16 v[72:75], v[152:155], v[80:83], v[72:75]
    s_waitcnt lgkmcnt(14)
    ds_read_b64 v[170:171], v28 offset:520
    v_mfma_f32_16x16x32_bf16 v[76:79], a[96:99], v[108:111], v[76:79]
    ds_read_b128 v[140:143], v29 offset:3616
    v_mfma_f32_16x16x32_bf16 v[76:79], a[100:103], v[104:107], v[76:79]
    ds_read_b64 v[172:173], v28 offset:0
    ds_read_b64 v[174:175], v28 offset:8
    v_mfma_f32_16x16x32_bf16 v[76:79], a[104:107], v[100:103], v[76:79]
    buffer_load_dwordx4 a[92:95], v5, s[32:35], s61 offen offset:0 sc1
    v_mfma_f32_16x16x32_bf16 v[76:79], a[108:111], v[96:99], v[76:79]
    s_waitcnt vmcnt(17)
    v_lshlrev_b32 v176, 16, v208
    v_and_b32 v178, 0xffff0000, v208
    v_mfma_f32_16x16x32_bf16 v[76:79], v[144:147], v[92:95], v[76:79]
    v_lshlrev_b32 v180, 16, v209
    v_and_b32 v182, 0xffff0000, v209
    v_mfma_f32_16x16x32_bf16 v[76:79], v[148:151], v[88:91], v[76:79]
    s_waitcnt vmcnt(16)
    v_fma_f32 v192, v176, v216, v217
    v_fma_f32 v194, v178, v216, v217
    v_mfma_f32_16x16x32_bf16 v[76:79], v[152:155], v[84:87], v[76:79]
    s_waitcnt lgkmcnt(15)
    v_fma_f32 v196, v180, v216, v217
    v_fma_f32 v198, v182, v216, v217
    v_mfma_f32_16x16x32_bf16 v[76:79], v[156:159], v[80:83], v[76:79]
    s_waitcnt lgkmcnt(15)
    v_fma_f32 v192, v192, v240, v244
    v_fma_f32 v194, v194, v241, v245
    v_mfma_f32_16x16x32_bf16 v[64:67], a[112:115], v[128:131], v[64:67]
    s_waitcnt lgkmcnt(14)
    buffer_load_dwordx4 a[96:99], v5, s[32:35], s61 offen offset:1024 sc1
    v_mfma_f32_16x16x32_bf16 v[64:67], a[116:119], v[124:127], v[64:67]
    s_waitcnt lgkmcnt(13)
    buffer_load_dwordx4 a[100:103], v5, s[32:35], s61 offen offset:2048 sc1
    v_mfma_f32_16x16x32_bf16 v[64:67], a[120:123], v[120:123], v[64:67]
    s_waitcnt lgkmcnt(12)
    s_add_u32 s61, s60, 55296
    v_fma_f32 v196, v196, v242, v246
    v_fma_f32 v198, v198, v243, v247
    v_mfma_f32_16x16x32_bf16 v[64:67], a[124:127], v[116:119], v[64:67]
    s_waitcnt lgkmcnt(9)
    v_mul_f32 v176, v24, v176
    v_mul_f32 v178, v25, v178
    v_mfma_f32_16x16x32_bf16 v[64:67], v[160:163], v[112:115], v[64:67]
    s_waitcnt lgkmcnt(8)
    s_mov_b32 s1, 22085632
    v_mul_f32 v180, v26, v180
    v_mul_f32 v182, v27, v182
    v_mfma_f32_16x16x32_bf16 v[68:71], a[112:115], v[132:135], v[68:71]
    buffer_load_dword v37, v14, s[32:35], s1 offen sc1
    v_mfma_f32_16x16x32_bf16 v[68:71], a[116:119], v[128:131], v[68:71]
    v_lshlrev_b32 v177, 16, v210
    v_and_b32 v179, 0xffff0000, v210
    v_mfma_f32_16x16x32_bf16 v[68:71], a[120:123], v[124:127], v[68:71]
    v_lshlrev_b32 v181, 16, v211
    v_and_b32 v183, 0xffff0000, v211
    v_mfma_f32_16x16x32_bf16 v[68:71], a[124:127], v[120:123], v[68:71]
    v_fma_f32 v193, v177, v218, v219
    v_fma_f32 v195, v179, v218, v219
    v_mfma_f32_16x16x32_bf16 v[68:71], v[160:163], v[116:119], v[68:71]
    s_waitcnt lgkmcnt(6)
    v_fma_f32 v197, v181, v218, v219
    v_fma_f32 v199, v183, v218, v219
    v_mfma_f32_16x16x32_bf16 v[68:71], v[164:167], v[112:115], v[68:71]
    s_waitcnt lgkmcnt(5)
    v_fma_f32 v193, v193, v240, v244
    v_fma_f32 v195, v195, v241, v245
    v_mfma_f32_16x16x32_bf16 v[72:75], a[112:115], v[136:139], v[72:75]
    v_fma_f32 v197, v197, v242, v246
    v_fma_f32 v199, v199, v243, v247
    v_mfma_f32_16x16x32_bf16 v[72:75], a[116:119], v[132:135], v[72:75]
    v_mul_f32 v177, v24, v177
    v_mul_f32 v179, v25, v179
    v_mfma_f32_16x16x32_bf16 v[72:75], a[120:123], v[128:131], v[72:75]
    v_mul_f32 v181, v26, v181
    v_mul_f32 v183, v27, v183
    v_mfma_f32_16x16x32_bf16 v[72:75], a[124:127], v[124:127], v[72:75]
    buffer_load_dwordx4 a[104:107], v4, s[32:35], s61 offen offset:0 sc1
    v_mfma_f32_16x16x32_bf16 v[72:75], v[160:163], v[120:123], v[72:75]
    s_waitcnt vmcnt(19)
    v_lshlrev_b32 v184, 16, v212
    v_and_b32 v186, 0xffff0000, v212
    v_mfma_f32_16x16x32_bf16 v[72:75], v[164:167], v[116:119], v[72:75]
    s_waitcnt lgkmcnt(3)
    v_lshlrev_b32 v188, 16, v213
    v_and_b32 v190, 0xffff0000, v213
    v_mfma_f32_16x16x32_bf16 v[72:75], v[168:171], v[112:115], v[72:75]
    s_waitcnt vmcnt(18) lgkmcnt(2)
    v_fma_f32 v200, v184, v220, v221
    v_fma_f32 v202, v186, v220, v221
    v_mfma_f32_16x16x32_bf16 v[76:79], a[112:115], v[140:143], v[76:79]
    buffer_load_dwordx4 a[108:111], v4, s[32:35], s61 offen offset:1024 sc1
    v_mfma_f32_16x16x32_bf16 v[76:79], a[116:119], v[136:139], v[76:79]
    v_fma_f32 v204, v188, v220, v221
    v_fma_f32 v206, v190, v220, v221
    v_mfma_f32_16x16x32_bf16 v[76:79], a[120:123], v[132:135], v[76:79]
    v_fma_f32 v200, v200, v240, v244
    v_fma_f32 v202, v202, v241, v245
    v_mfma_f32_16x16x32_bf16 v[76:79], a[124:127], v[128:131], v[76:79]
    v_fma_f32 v204, v204, v242, v246
    v_fma_f32 v206, v206, v243, v247
    v_mfma_f32_16x16x32_bf16 v[76:79], v[160:163], v[124:127], v[76:79]
    v_mul_f32 v184, v24, v184
    v_mul_f32 v186, v25, v186
    v_mfma_f32_16x16x32_bf16 v[76:79], v[164:167], v[120:123], v[76:79]
    v_mul_f32 v188, v26, v188
    v_mul_f32 v190, v27, v190
    v_mfma_f32_16x16x32_bf16 v[76:79], v[168:171], v[116:119], v[76:79]
    s_waitcnt lgkmcnt(0)
    v_lshlrev_b32 v185, 16, v214
    v_and_b32 v187, 0xffff0000, v214
    v_mfma_f32_16x16x32_bf16 v[76:79], v[172:175], v[112:115], v[76:79]
    v_lshlrev_b32 v189, 16, v215
    v_and_b32 v191, 0xffff0000, v215
    v_fma_f32 v201, v185, v222, v223
    v_fma_f32 v203, v187, v222, v223
    v_fma_f32 v205, v189, v222, v223
    v_fma_f32 v207, v191, v222, v223
    v_fma_f32 v201, v201, v240, v244
    v_fma_f32 v203, v203, v241, v245
    v_fma_f32 v205, v205, v242, v246
    v_fma_f32 v207, v207, v243, v247
    v_mul_f32 v185, v24, v185
    v_mul_f32 v187, v25, v187
    v_mul_f32 v189, v26, v189
    v_mul_f32 v191, v27, v191
    ds_write_b128 v30, v[64:67] offset:0
    ds_write_b128 v30, v[68:71] offset:1024
    ds_write_b128 v30, v[72:75] offset:2048
    ds_write_b128 v30, v[76:79] offset:3072
    s_waitcnt lgkmcnt(0)
    s_barrier
    ds_read_b64 v[224:225], v31 offset:0
    ds_read_b64 v[226:227], v31 offset:4096
    ds_read_b64 v[228:229], v31 offset:8192
    ds_read_b64 v[230:231], v31 offset:12288
    ds_read_b64 v[232:233], v31 offset:2048
    ds_read_b64 v[234:235], v31 offset:6144
    ds_read_b64 v[236:237], v31 offset:10240
    ds_read_b64 v[238:239], v31 offset:14336
    s_waitcnt lgkmcnt(7)
    v_pk_fma_f32 v[224:225], v[192:193], v[224:225], v[176:177]
    s_waitcnt lgkmcnt(6)
    v_pk_fma_f32 v[226:227], v[194:195], v[226:227], v[178:179]
    s_waitcnt lgkmcnt(5)
    v_pk_fma_f32 v[228:229], v[196:197], v[228:229], v[180:181]
    s_waitcnt lgkmcnt(4)
    v_pk_fma_f32 v[230:231], v[198:199], v[230:231], v[182:183]
    v_cvt_pk_bf16_f32 v248, v224, v226
    v_cvt_pk_bf16_f32 v249, v228, v230
    v_cvt_pk_bf16_f32 v250, v225, v227
    v_cvt_pk_bf16_f32 v251, v229, v231
    s_add_u32 s53, s52, 6299648
    buffer_store_dwordx4 v[248:251], v32, s[32:35], s53 offen sc1
    s_waitcnt lgkmcnt(3)
    v_pk_fma_f32 v[232:233], v[200:201], v[232:233], v[184:185]
    s_waitcnt lgkmcnt(2)
    v_pk_fma_f32 v[234:235], v[202:203], v[234:235], v[186:187]
    s_waitcnt lgkmcnt(1)
    v_pk_fma_f32 v[236:237], v[204:205], v[236:237], v[188:189]
    s_waitcnt lgkmcnt(0)
    v_pk_fma_f32 v[238:239], v[206:207], v[238:239], v[190:191]
    v_cvt_pk_bf16_f32 v252, v232, v234
    v_cvt_pk_bf16_f32 v253, v236, v238
    v_cvt_pk_bf16_f32 v254, v233, v235
    v_cvt_pk_bf16_f32 v255, v237, v239
    s_add_u32 s53, s52, 6303744
    buffer_store_dwordx4 v[252:255], v32, s[32:35], s53 offen sc1
    s_waitcnt vmcnt(4)
    v_cmp_ne_u32 vcc, v2, v37
    s_nop 1
    s_cbranch_vccnz Lspin5
Lback5:
    s_barrier
    s_add_u32 m0, s0, 122880
    s_add_u32 s63, s90, 0
    buffer_load_dwordx4 v10, s[32:35], s63 offen sc1 lds
    buffer_load_dwordx4 v11, s[32:35], s63 offen offset:1024 sc1 lds
    s_add_u32 m0, s0, 131072
    s_add_u32 s63, s90, 524288
    buffer_load_dwordx4 v10, s[32:35], s63 offen sc1 lds
    buffer_load_dwordx4 v11, s[32:35], s63 offen offset:1024 sc1 lds
    s_add_u32 m0, s0, 139264
    s_add_u32 s63, s90, 1048576
    buffer_load_dwordx4 v10, s[32:35], s63 offen sc1 lds
    buffer_load_dwordx4 v11, s[32:35], s63 offen offset:1024 sc1 lds
    s_add_u32 m0, s0, 147456
    s_add_u32 s63, s90, 1572864
    buffer_load_dwordx4 v10, s[32:35], s63 offen sc1 lds
    buffer_load_dwordx4 v11, s[32:35], s63 offen offset:1024 sc1 lds
    s_add_u32 m0, s0, 155648
    s_add_u32 s63, s90, 2097152
    buffer_load_dwordx4 v10, s[32:35], s63 offen sc1 lds
    buffer_load_dwordx4 v11, s[32:35], s63 offen offset:1024 sc1 lds
    v_lshrrev_b32 v170, 5, v1
    v_lshl_add_u32 v170, v170, 31, v4
    s_mov_b32 s54, 425984
    buffer_load_dwordx4 v[152:155], v4, s[32:35], s54 offen sc1
    buffer_load_dwordx4 v[156:159], v4, s[32:35], s54 offen offset:1024 sc1
    buffer_load_dwordx4 v[160:163], v170, s[32:35], s54 offen offset:2048 sc1
    s_branch LG
.p2align 12
LG:
Lh6:
LhopW2:
    s_cbranch_execz Lh10
    s_cmp_lt_u32 s50, 20
    s_cselect_b32 s7, 0, 928
    s_add_u32 s7, s7, s45
    s_mov_b32 s4, 22073344
    buffer_load_dword v181, v16, s[32:35], s4 offen sc1
    s_waitcnt vmcnt(4)
    s_barrier
    ds_read_b64 v[24:25], v8 offset:0
    ds_read_b64 v[26:27], v8 offset:1024
    ds_read_b64 v[28:29], v22 offset:2048
    ds_read_b64 v[30:31], v22 offset:3072
    ds_read_b64 v[32:33], v9 offset:0
    ds_read_b64 v[34:35], v9 offset:1024
    ds_read_b64 v[36:37], v23 offset:2048
    ds_read_b64 v[38:39], v23 offset:3072
    s_waitcnt lgkmcnt(6)
    v_mfma_f32_16x16x32_bf16 v[56:59], a[128:131], v[24:27], 0
    s_waitcnt lgkmcnt(4)
    s_lshl_b32 s52, s7, 7
    ds_read2st64_b64 v[40:43], v8 offset0:8 offset1:10
    v_lshrrev_b32 v170, 5, v1
    v_mfma_f32_16x16x32_bf16 v[56:59], a[140:143], v[28:31], v[56:59]
    s_add_u32 s52, s52, 22106112
    ds_read2st64_b64 v[44:47], v22 offset0:12 offset1:14
    v_lshlrev_b32 v170, 14, v170
    v_mfma_f32_16x16x32_bf16 v[60:63], a[132:135], v[24:27], 0
    buffer_store_dword v2, v3, s[32:35], s52 offen sc1
    v_mfma_f32_16x16x32_bf16 v[60:63], a[144:147], v[28:31], v[60:63]
    s_add_u32 s61, s60, 55296
    ds_read2st64_b64 v[48:51], v9 offset0:8 offset1:10
    v_sub_u32 v170, v19, v170
    v_mfma_f32_16x16x32_bf16 v[64:67], a[136:139], v[24:27], 0
    buffer_load_dwordx4 a[112:115], v4, s[32:35], s61 offen offset:2048 sc1
    v_mfma_f32_16x16x32_bf16 v[64:67], a[148:151], v[28:31], v[64:67]
    s_waitcnt lgkmcnt(3)
    ds_read_b64 v[164:165], v19
    v_mfma_f32_16x16x32_bf16 v[68:71], a[128:131], v[32:35], 0
Lh7:
LhopW3:
    s_cbranch_execz Lh11
    ds_read_b64 v[166:167], v19 offset:16384
    ds_read2st64_b64 v[52:55], v23 offset0:12 offset1:14
    v_mfma_f32_16x16x32_bf16 v[68:71], a[140:143], v[36:39], v[68:71]
    buffer_load_dwordx4 a[116:119], v5, s[32:35], s61 offen offset:0 sc1
    v_mfma_f32_16x16x32_bf16 v[72:75], a[132:135], v[32:35], 0
    buffer_load_dwordx4 a[120:123], v5, s[32:35], s61 offen offset:1024 sc1
    v_mfma_f32_16x16x32_bf16 v[72:75], a[144:147], v[36:39], v[72:75]
    ds_read_b64 v[168:169], v170 offset:32768
    v_mfma_f32_16x16x32_bf16 v[76:79], a[136:139], v[32:35], 0
    buffer_load_dwordx4 a[124:127], v5, s[32:35], s61 offen offset:2048 sc1
    v_mfma_f32_16x16x32_bf16 v[76:79], a[148:151], v[36:39], v[76:79]
    s_waitcnt lgkmcnt(5)
    s_add_u32 m0, s0, 0
    s_add_u32 s63, s91, 0
    v_mfma_f32_16x16x32_bf16 v[56:59], a[152:155], v[40:43], v[56:59]
    s_waitcnt lgkmcnt(3)
    ds_read2st64_b64 v[24:27], v8 offset0:16 offset1:18
    v_lshlrev_b32 v128, 16, v164
    v_and_b32 v129, 0xffff0000, v164
    v_mfma_f32_16x16x32_bf16 v[56:59], a[164:167], v[44:47], v[56:59]
    ds_read2st64_b64 v[28:31], v22 offset0:20 offset1:22
    v_lshlrev_b32 v130, 16, v165
    v_and_b32 v131, 0xffff0000, v165
    v_mfma_f32_16x16x32_bf16 v[60:63], a[156:159], v[40:43], v[60:63]
    s_waitcnt lgkmcnt(4)
    buffer_load_dwordx4 v10, s[32:35], s63 offen sc1 lds
    v_lshlrev_b32 v132, 16, v166
    v_mfma_f32_16x16x32_bf16 v[60:63], a[168:171], v[44:47], v[60:63]
    ds_read2st64_b64 v[32:35], v9 offset0:16 offset1:18
    v_and_b32 v133, 0xffff0000, v166
    v_lshlrev_b32 v134, 16, v167
    v_mfma_f32_16x16x32_bf16 v[64:67], a[160:163], v[40:43], v[64:67]
    s_waitcnt lgkmcnt(3)
    ds_read2st64_b64 v[36:39], v23 offset0:20 offset1:22
    v_and_b32 v135, 0xffff0000, v167
    v_lshlrev_b32 v136, 16, v168
    v_mfma_f32_16x16x32_bf16 v[64:67], a[172:175], v[44:47], v[64:67]
Lh8:
LhopW0:
    s_cbranch_execz Lh12
    v_and_b32 v137, 0xffff0000, v168
    v_lshlrev_b32 v138, 16, v169
    v_and_b32 v139, 0xffff0000, v169
    v_mfma_f32_16x16x32_bf16 v[68:71], a[152:155], v[48:51], v[68:71]
    buffer_load_dwordx4 v11, s[32:35], s63 offen offset:1024 sc1 lds
    v_mfma_f32_16x16x32_bf16 v[68:71], a[164:167], v[52:55], v[68:71]
    s_waitcnt vmcnt(9)
    s_add_u32 m0, s0, 8192
    v_pk_mul_f32 v[128:129], v[128:129], v[152:153]
    v_pk_mul_f32 v[130:131], v[130:131], v[154:155]
    v_pk_mul_f32 v[132:133], v[132:133], v[156:157]
    v_pk_mul_f32 v[134:135], v[134:135], v[158:159]
    s_waitcnt vmcnt(8)
    v_pk_mul_f32 v[136:137], v[136:137], v[160:161]
    v_pk_mul_f32 v[138:139], v[138:139], v[162:163]
    v_pk_add_f32 v[170:171], v[128:129], v[130:131]
    v_pk_mul_f32 v[172:173], v[128:129], v[128:129]
    v_pk_fma_f32 v[172:173], v[130:131], v[130:131], v[172:173]
    v_pk_add_f32 v[170:171], v[170:171], v[132:133]
    v_pk_fma_f32 v[172:173], v[132:133], v[132:133], v[172:173]
    v_pk_add_f32 v[170:171], v[170:171], v[134:135]
    v_pk_fma_f32 v[172:173], v[134:135], v[134:135], v[172:173]
    v_pk_add_f32 v[170:171], v[170:171], v[136:137]
    v_pk_fma_f32 v[172:173], v[136:137], v[136:137], v[172:173]
    v_pk_add_f32 v[170:171], v[170:171], v[138:139]
    v_pk_fma_f32 v[172:173], v[138:139], v[138:139], v[172:173]
    v_add_f32 v174, v170, v171
    v_mfma_f32_16x16x32_bf16 v[72:75], a[156:159], v[48:51], v[72:75]
    s_waitcnt vmcnt(7)
    s_add_u32 s63, s91, 524288
    v_cmp_ne_u32 vcc, v2, v181
    s_nop 1
    s_cbranch_vccnz Lspin7
Lback7:
    v_add_f32 v175, v172, v173
    v_mfma_f32_16x16x32_bf16 v[72:75], a[168:171], v[52:55], v[72:75]
    buffer_load_dwordx4 v10, s[32:35], s63 offen sc1 lds
    v_add_f32_dpp v174, v174, v174 row_ror:8 row_mask:0xf bank_mask:0xf
    v_mfma_f32_16x16x32_bf16 v[76:79], a[160:163], v[48:51], v[76:79]
    s_add_u32 s66, s65, 0
    v_add_f32_dpp v175, v175, v175 row_ror:8 row_mask:0xf bank_mask:0xf
    v_add_f32_dpp v174, v174, v174 row_ror:4 row_mask:0xf bank_mask:0xf
    s_nop 0
    v_add_f32_dpp v175, v175, v175 row_ror:4 row_mask:0xf bank_mask:0xf
    v_mfma_f32_16x16x32_bf16 v[76:79], a[172:175], v[52:55], v[76:79]
    s_waitcnt lgkmcnt(2)
    v_add_f32_dpp v174, v174, v174 row_ror:2 row_mask:0xf bank_mask:0xf
    v_add_f32_dpp v175, v175, v175 row_ror:2 row_mask:0xf bank_mask:0xf
    s_nop 0
    v_add_f32_dpp v174, v174, v174 row_ror:1 row_mask:0xf bank_mask:0xf
    v_mfma_f32_16x16x32_bf16 v[56:59], a[176:179], v[24:27], v[56:59]
    ds_read2st64_b64 v[40:43], v8 offset0:24 offset1:26
    v_add_f32_dpp v175, v175, v175 row_ror:1 row_mask:0xf bank_mask:0xf
    v_add_f32_dpp v174, v174, v174 row_bcast:15 row_mask:0xa bank_mask:0xf
    v_mfma_f32_16x16x32_bf16 v[56:59], a[188:191], v[28:31], v[56:59]
    buffer_load_dwordx4 v11, s[32:35], s63 offen offset:1024 sc1 lds
    v_add_f32_dpp v175, v175, v175 row_bcast:15 row_mask:0xa bank_mask:0xf
    v_mfma_f32_16x16x32_bf16 v[60:63], a[180:183], v[24:27], v[60:63]
    s_add_u32 m0, s0, 16384
    ds_read2st64_b64 v[44:47], v22 offset0:28 offset1:30
    v_add_f32_dpp v174, v174, v174 row_bcast:31 row_mask:0xc bank_mask:0xf
    v_add_f32_dpp v175, v175, v175 row_bcast:31 row_mask:0xc bank_mask:0xf
    v_mfma_f32_16x16x32_bf16 v[60:63], a[192:195], v[28:31], v[60:63]
    s_add_u32 s63, s91, 1048576
    ds_read2st64_b64 v[48:51], v9 offset0:24 offset1:26
    v_mul_f32 v174, 0x3acccccd, v174
    v_mul_f32 v175, 0x3acccccd, v175
    v_mfma_f32_16x16x32_bf16 v[64:67], a[184:187], v[24:27], v[64:67]
    buffer_load_dwordx4 v10, s[32:35], s63 offen sc1 lds
    v_mov_b32 v165, v2
    v_mfma_f32_16x16x32_bf16 v[64:67], a[196:199], v[28:31], v[64:67]
    s_waitcnt lgkmcnt(3)
    ds_read2st64_b64 v[52:55], v23 offset0:28 offset1:30
    v_fma_f32 v175, -v174, v174, v175
    v_max_f32 v175, 0, v175
    v_mfma_f32_16x16x32_bf16 v[68:71], a[176:179], v[32:35], v[68:71]
    s_lshl_b32 s54, s48, 9
    v_lshrrev_b32 v15, 4, v1
    v_lshl_add_u32 v15, v15, 7, s54
    v_add_f32 v175, 0x3727c5ac, v175
    v_mfma_f32_16x16x32_bf16 v[68:71], a[188:191], v[36:39], v[68:71]
    s_mov_b32 s9, 22237184
    v_rsq_f32 v164, v175
    v_mov_b32 v167, v2
    v_mfma_f32_16x16x32_bf16 v[72:75], a[180:183], v[32:35], v[72:75]
    buffer_load_dwordx4 v11, s[32:35], s63 offen offset:1024 sc1 lds
    v_mul_f32_e64 v166, -v174, v164
    v_mfma_f32_16x16x32_bf16 v[72:75], a[192:195], v[36:39], v[72:75]
    buffer_load_dword v182, v15, s[32:35], s9 offen sc1
    v_mfma_f32_16x16x32_bf16 v[76:79], a[184:187], v[32:35], v[76:79]
    s_add_u32 m0, s0, 24576
    s_add_u32 s63, s91, 1572864
    s_add_u32 s53, s70, 0
    v_mfma_f32_16x16x32_bf16 v[76:79], a[196:199], v[36:39], v[76:79]
    s_waitcnt lgkmcnt(2)
    v_mfma_f32_16x16x32_bf16 v[56:59], a[200:203], v[40:43], v[56:59]
    buffer_store_dwordx4 v[164:167], v20, s[32:35], s53 offen sc1
    v_mfma_f32_16x16x32_bf16 v[56:59], a[212:215], v[44:47], v[56:59]
    ds_read2st64_b64 v[24:27], v8 offset0:32 offset1:34
    v_mfma_f32_16x16x32_bf16 v[60:63], a[204:207], v[40:43], v[60:63]
    ds_read2st64_b64 v[28:31], v22 offset0:36 offset1:38
    v_mfma_f32_16x16x32_bf16 v[60:63], a[216:219], v[44:47], v[60:63]
    ds_read2st64_b64 v[32:35], v9 offset0:32 offset1:34
    v_mfma_f32_16x16x32_bf16 v[64:67], a[208:211], v[40:43], v[64:67]
    ds_read2st64_b64 v[36:39], v23 offset0:36 offset1:38
    v_mfma_f32_16x16x32_bf16 v[64:67], a[220:223], v[44:47], v[64:67]
    s_waitcnt lgkmcnt(4)
    v_mfma_f32_16x16x32_bf16 v[68:71], a[200:203], v[48:51], v[68:71]
    v_mfma_f32_16x16x32_bf16 v[68:71], a[212:215], v[52:55], v[68:71]
    buffer_load_dwordx4 v10, s[32:35], s63 offen sc1 lds
    v_mfma_f32_16x16x32_bf16 v[72:75], a[204:207], v[48:51], v[72:75]
    v_mfma_f32_16x16x32_bf16 v[72:75], a[216:219], v[52:55], v[72:75]
    v_mfma_f32_16x16x32_bf16 v[76:79], a[208:211], v[48:51], v[76:79]
    buffer_load_dwordx4 v11, s[32:35], s63 offen offset:1024 sc1 lds
    v_mfma_f32_16x16x32_bf16 v[76:79], a[220:223], v[52:55], v[76:79]
    s_waitcnt lgkmcnt(2)
    s_add_u32 m0, s0, 32768
    s_add_u32 s63, s91, 2097152
    v_mfma_f32_16x16x32_bf16 v[56:59], a[224:227], v[24:27], v[56:59]
    ds_read2st64_b64 v[40:43], v8 offset0:40 offset1:42
    v_mfma_f32_16x16x32_bf16 v[56:59], a[236:239], v[28:31], v[56:59]
    ds_read2st64_b64 v[44:47], v22 offset0:44 offset1:46
    v_mfma_f32_16x16x32_bf16 v[60:63], a[228:231], v[24:27], v[60:63]
    buffer_load_dwordx4 v10, s[32:35], s63 offen sc1 lds
    v_mfma_f32_16x16x32_bf16 v[60:63], a[0:3], v[28:31], v[60:63]
    ds_read2st64_b64 v[48:51], v9 offset0:40 offset1:42
    v_mfma_f32_16x16x32_bf16 v[64:67], a[232:235], v[24:27], v[64:67]
    ds_read2st64_b64 v[52:55], v23 offset0:44 offset1:46
    v_mfma_f32_16x16x32_bf16 v[64:67], a[4:7], v[28:31], v[64:67]
    s_waitcnt lgkmcnt(4)
    v_mfma_f32_16x16x32_bf16 v[68:71], a[224:227], v[32:35], v[68:71]
    buffer_load_dwordx4 v11, s[32:35], s63 offen offset:1024 sc1 lds
    v_mfma_f32_16x16x32_bf16 v[68:71], a[236:239], v[36:39], v[68:71]
    v_mfma_f32_16x16x32_bf16 v[72:75], a[228:231], v[32:35], v[72:75]
    v_mfma_f32_16x16x32_bf16 v[72:75], a[0:3], v[36:39], v[72:75]
    buffer_load_dwordx4 v[184:187], v4, s[32:35], s66 offen offset:0 sc1
    v_mfma_f32_16x16x32_bf16 v[76:79], a[232:235], v[32:35], v[76:79]
    v_mfma_f32_16x16x32_bf16 v[76:79], a[4:7], v[36:39], v[76:79]
    s_waitcnt lgkmcnt(2)
    v_mfma_f32_16x16x32_bf16 v[56:59], a[8:11], v[40:43], v[56:59]
    ds_read2st64_b64 v[24:27], v8 offset0:48 offset1:50
    v_mfma_f32_16x16x32_bf16 v[56:59], a[20:23], v[44:47], v[56:59]
    buffer_load_dwordx4 v[188:191], v4, s[32:35], s66 offen offset:1024 sc1
    v_mfma_f32_16x16x32_bf16 v[60:63], a[12:15], v[40:43], v[60:63]
    ds_read2st64_b64 v[28:31], v22 offset0:52 offset1:54
    v_mfma_f32_16x16x32_bf16 v[60:63], a[24:27], v[44:47], v[60:63]
    ds_read2st64_b64 v[32:35], v9 offset0:48 offset1:50
    v_mfma_f32_16x16x32_bf16 v[64:67], a[16:19], v[40:43], v[64:67]
    buffer_load_dwordx4 v[192:195], v4, s[32:35], s66 offen offset:2048 sc1
    v_mfma_f32_16x16x32_bf16 v[64:67], a[28:31], v[44:47], v[64:67]
    s_waitcnt lgkmcnt(3)
    ds_read2st64_b64 v[36:39], v23 offset0:52 offset1:54
    v_mfma_f32_16x16x32_bf16 v[68:71], a[8:11], v[48:51], v[68:71]
    v_mfma_f32_16x16x32_bf16 v[68:71], a[20:23], v[52:55], v[68:71]
    v_mfma_f32_16x16x32_bf16 v[72:75], a[12:15], v[48:51], v[72:75]
    buffer_load_dwordx4 v[196:199], v4, s[32:35], s66 offen offset:3072 sc1
    v_mfma_f32_16x16x32_bf16 v[72:75], a[24:27], v[52:55], v[72:75]
    v_mfma_f32_16x16x32_bf16 v[76:79], a[16:19], v[48:51], v[76:79]
    v_mfma_f32_16x16x32_bf16 v[76:79], a[28:31], v[52:55], v[76:79]
    s_waitcnt lgkmcnt(2)
    v_mfma_f32_16x16x32_bf16 v[56:59], a[32:35], v[24:27], v[56:59]
    buffer_load_dwordx4 v[200:203], v6, s[32:35], s66 offen offset:0 sc1
    v_mfma_f32_16x16x32_bf16 v[56:59], a[44:47], v[28:31], v[56:59]
    s_waitcnt vmcnt(10)
    s_add_u32 s66, s65, 5120
    ds_read2st64_b64 v[40:43], v8 offset0:56 offset1:58
    v_cmp_ne_u32 vcc, v2, v182
    s_nop 1
    s_cbranch_vccnz Lspin13
Lback13:
    v_mfma_f32_16x16x32_bf16 v[60:63], a[36:39], v[24:27], v[60:63]
    s_mov_b32 s54, 294912
    ds_read2st64_b64 v[44:47], v22 offset0:60 offset1:62
    s_mov_b32 s55, 360448
    v_mfma_f32_16x16x32_bf16 v[60:63], a[48:51], v[28:31], v[60:63]
    buffer_load_dwordx4 v[104:107], v17, s[32:35], s54 offen offset:0 sc1
    v_mfma_f32_16x16x32_bf16 v[64:67], a[40:43], v[24:27], v[64:67]
    ds_read2st64_b64 v[48:51], v9 offset0:56 offset1:58
    v_mfma_f32_16x16x32_bf16 v[64:67], a[52:55], v[28:31], v[64:67]
    s_waitcnt lgkmcnt(3)
    ds_read2st64_b64 v[52:55], v23 offset0:60 offset1:62
    v_mfma_f32_16x16x32_bf16 v[68:71], a[32:35], v[32:35], v[68:71]
    v_mfma_f32_16x16x32_bf16 v[68:71], a[44:47], v[36:39], v[68:71]
    buffer_load_dwordx4 v[116:119], v17, s[32:35], s55 offen offset:0 sc1
    v_mfma_f32_16x16x32_bf16 v[72:75], a[36:39], v[32:35], v[72:75]
    v_mfma_f32_16x16x32_bf16 v[72:75], a[48:51], v[36:39], v[72:75]
    v_mfma_f32_16x16x32_bf16 v[76:79], a[40:43], v[32:35], v[76:79]
    buffer_load_dwordx4 v[108:111], v17, s[32:35], s54 offen offset:64 sc1
    v_mfma_f32_16x16x32_bf16 v[76:79], a[52:55], v[36:39], v[76:79]
    s_waitcnt lgkmcnt(2)
    v_mfma_f32_16x16x32_bf16 v[56:59], a[56:59], v[40:43], v[56:59]
    ds_read2st64_b64 v[24:27], v8 offset0:64 offset1:66
    v_mfma_f32_16x16x32_bf16 v[56:59], a[68:71], v[44:47], v[56:59]
    ds_read2st64_b64 v[28:31], v22 offset0:68 offset1:70
    v_mfma_f32_16x16x32_bf16 v[60:63], a[60:63], v[40:43], v[60:63]
    buffer_load_dwordx4 v[120:123], v17, s[32:35], s55 offen offset:64 sc1
    v_mfma_f32_16x16x32_bf16 v[60:63], a[72:75], v[44:47], v[60:63]
    ds_read2st64_b64 v[32:35], v9 offset0:64 offset1:66
    v_mfma_f32_16x16x32_bf16 v[64:67], a[64:67], v[40:43], v[64:67]
    ds_read2st64_b64 v[36:39], v23 offset0:68 offset1:70
    v_mfma_f32_16x16x32_bf16 v[64:67], a[76:79], v[44:47], v[64:67]
    s_waitcnt lgkmcnt(4)
    v_mfma_f32_16x16x32_bf16 v[68:71], a[56:59], v[48:51], v[68:71]
    buffer_load_dwordx4 v[112:115], v17, s[32:35], s54 offen offset:128 sc1
    v_mfma_f32_16x16x32_bf16 v[68:71], a[68:71], v[52:55], v[68:71]
    v_mfma_f32_16x16x32_bf16 v[72:75], a[60:63], v[48:51], v[72:75]
    v_mfma_f32_16x16x32_bf16 v[72:75], a[72:75], v[52:55], v[72:75]
    buffer_load_dwordx4 v[124:127], v17, s[32:35], s55 offen offset:128 sc1
    v_mfma_f32_16x16x32_bf16 v[76:79], a[64:67], v[48:51], v[76:79]
    v_mfma_f32_16x16x32_bf16 v[76:79], a[76:79], v[52:55], v[76:79]
    s_waitcnt lgkmcnt(2)
    v_mfma_f32_16x16x32_bf16 v[56:59], a[80:83], v[24:27], v[56:59]
    ds_read2st64_b64 v[40:43], v8 offset0:72 offset1:74
    v_mfma_f32_16x16x32_bf16 v[56:59], a[92:95], v[28:31], v[56:59]
    buffer_load_dwordx4 v[204:207], v4, s[32:35], s66 offen offset:0 sc1
    v_mfma_f32_16x16x32_bf16 v[60:63], a[84:87], v[24:27], v[60:63]
    ds_read2st64_b64 v[44:47], v22 offset0:76 offset1:78
    v_mfma_f32_16x16x32_bf16 v[60:63], a[96:99], v[28:31], v[60:63]
    ds_read2st64_b64 v[48:51], v9 offset0:72 offset1:74
    v_mfma_f32_16x16x32_bf16 v[64:67], a[88:91], v[24:27], v[64:67]
    buffer_load_dwordx4 v[208:211], v4, s[32:35], s66 offen offset:1024 sc1
    v_mfma_f32_16x16x32_bf16 v[64:67], a[100:103], v[28:31], v[64:67]
    s_waitcnt lgkmcnt(3)
    ds_read2st64_b64 v[52:55], v23 offset0:76 offset1:78
    v_mfma_f32_16x16x32_bf16 v[68:71], a[80:83], v[32:35], v[68:71]
    v_mfma_f32_16x16x32_bf16 v[68:71], a[92:95], v[36:39], v[68:71]
    v_mfma_f32_16x16x32_bf16 v[72:75], a[84:87], v[32:35], v[72:75]
    buffer_load_dwordx4 v[212:215], v4, s[32:35], s66 offen offset:2048 sc1
    v_mfma_f32_16x16x32_bf16 v[72:75], a[96:99], v[36:39], v[72:75]
    v_subrev_u32 v8, 122880, v8
    v_subrev_u32 v22, 122880, v22
    v_mfma_f32_16x16x32_bf16 v[76:79], a[88:91], v[32:35], v[76:79]
    v_subrev_u32 v9, 122880, v9
    v_subrev_u32 v23, 122880, v23
    v_mfma_f32_16x16x32_bf16 v[76:79], a[100:103], v[36:39], v[76:79]
    s_waitcnt lgkmcnt(2) vmcnt(14)
    s_barrier
    v_mfma_f32_16x16x32_bf16 v[56:59], a[104:107], v[40:43], v[56:59]
    buffer_load_dwordx4 v[216:219], v4, s[32:35], s66 offen offset:3072 sc1
    v_mfma_f32_16x16x32_bf16 v[56:59], a[116:119], v[44:47], v[56:59]
    ds_read2st64_b64 v[24:27], v8 offset0:0 offset1:2
    v_mfma_f32_16x16x32_bf16 v[60:63], a[108:111], v[40:43], v[60:63]
    s_mov_b32 s1, 22106112
    ds_read2st64_b64 v[28:31], v22 offset0:4 offset1:6
    v_mfma_f32_16x16x32_bf16 v[60:63], a[120:123], v[44:47], v[60:63]
    buffer_load_dword v180, v14, s[32:35], s1 offen sc1
    v_mfma_f32_16x16x32_bf16 v[64:67], a[112:115], v[40:43], v[64:67]
    ds_read2st64_b64 v[32:35], v9 offset0:0 offset1:2
    v_mfma_f32_16x16x32_bf16 v[64:67], a[124:127], v[44:47], v[64:67]
    s_waitcnt lgkmcnt(3)
    ds_read2st64_b64 v[36:39], v23 offset0:4 offset1:6
    v_mfma_f32_16x16x32_bf16 v[68:71], a[104:107], v[48:51], v[68:71]
    v_mfma_f32_16x16x32_bf16 v[68:71], a[116:119], v[52:55], v[68:71]
    v_mfma_f32_16x16x32_bf16 v[72:75], a[108:111], v[48:51], v[72:75]
    v_mfma_f32_16x16x32_bf16 v[72:75], a[120:123], v[52:55], v[72:75]
    v_mfma_f32_16x16x32_bf16 v[76:79], a[112:115], v[48:51], v[76:79]
    v_mfma_f32_16x16x32_bf16 v[76:79], a[124:127], v[52:55], v[76:79]
    s_waitcnt lgkmcnt(2)
    v_mfma_f32_16x16x32_bf16 v[80:83], a[128:131], v[24:27], 0
    ds_read2st64_b64 v[40:43], v8 offset0:8 offset1:10
    v_mfma_f32_16x16x32_bf16 v[80:83], a[140:143], v[28:31], v[80:83]
    buffer_load_dwordx4 v[220:223], v6, s[32:35], s66 offen offset:0 sc1
    v_mfma_f32_16x16x32_bf16 v[84:87], a[132:135], v[24:27], 0
    s_add_u32 s66, s65, 10240
    ds_read2st64_b64 v[44:47], v22 offset0:12 offset1:14
    v_mfma_f32_16x16x32_bf16 v[84:87], a[144:147], v[28:31], v[84:87]
    ds_read2st64_b64 v[48:51], v9 offset0:8 offset1:10
    v_mfma_f32_16x16x32_bf16 v[88:91], a[136:139], v[24:27], 0
    ds_read2st64_b64 v[52:55], v23 offset0:12 offset1:14
    v_mfma_f32_16x16x32_bf16 v[88:91], a[148:151], v[28:31], v[88:91]
    s_waitcnt lgkmcnt(4)
    s_add_u32 s8, s70, 0
    v_mfma_f32_16x16x32_bf16 v[92:95], a[128:131], v[32:35], 0
    buffer_load_dwordx4 v[176:179], v21, s[32:35], s8 offen sc1
    v_mfma_f32_16x16x32_bf16 v[92:95], a[140:143], v[36:39], v[92:95]
    v_mfma_f32_16x16x32_bf16 v[96:99], a[132:135], v[32:35], 0
    buffer_load_dwordx4 v[224:227], v4, s[32:35], s66 offen offset:0 sc1
    v_mfma_f32_16x16x32_bf16 v[96:99], a[144:147], v[36:39], v[96:99]
    v_mfma_f32_16x16x32_bf16 v[100:103], a[136:139], v[32:35], 0
    v_mfma_f32_16x16x32_bf16 v[100:103], a[148:151], v[36:39], v[100:103]
    s_waitcnt lgkmcnt(2)
    v_mfma_f32_16x16x32_bf16 v[80:83], a[152:155], v[40:43], v[80:83]
    buffer_load_dwordx4 v[228:231], v4, s[32:35], s66 offen offset:1024 sc1
    v_mfma_f32_16x16x32_bf16 v[80:83], a[164:167], v[44:47], v[80:83]
    ds_read2st64_b64 v[24:27], v8 offset0:16 offset1:18
    v_mfma_f32_16x16x32_bf16 v[84:87], a[156:159], v[40:43], v[84:87]
    s_waitcnt vmcnt(14)
    ds_read2st64_b64 v[28:31], v22 offset0:20 offset1:22
    v_add_f32_dpp v104, v104, v104 row_ror:4 row_mask:0xf bank_mask:0xf
    v_mfma_f32_16x16x32_bf16 v[84:87], a[168:171], v[44:47], v[84:87]
    buffer_load_dwordx4 v[232:235], v4, s[32:35], s66 offen offset:2048 sc1
    v_mfma_f32_16x16x32_bf16 v[88:91], a[160:163], v[40:43], v[88:91]
    ds_read2st64_b64 v[32:35], v9 offset0:16 offset1:18
    v_add_f32_dpp v105, v105, v105 row_ror:4 row_mask:0xf bank_mask:0xf
    v_mfma_f32_16x16x32_bf16 v[88:91], a[172:175], v[44:47], v[88:91]
    s_waitcnt lgkmcnt(3)
    ds_read2st64_b64 v[36:39], v23 offset0:20 offset1:22
    v_add_f32_dpp v106, v106, v106 row_ror:4 row_mask:0xf bank_mask:0xf
    v_mfma_f32_16x16x32_bf16 v[92:95], a[152:155], v[48:51], v[92:95]
    s_waitcnt vmcnt(13)
    v_add_f32_dpp v107, v107, v107 row_ror:4 row_mask:0xf bank_mask:0xf
    v_add_f32_dpp v108, v108, v108 row_ror:4 row_mask:0xf bank_mask:0xf
    v_mfma_f32_16x16x32_bf16 v[92:95], a[164:167], v[52:55], v[92:95]
    buffer_load_dwordx4 v[236:239], v4, s[32:35], s66 offen offset:3072 sc1
    v_mfma_f32_16x16x32_bf16 v[96:99], a[156:159], v[48:51], v[96:99]
    v_add_f32_dpp v109, v109, v109 row_ror:4 row_mask:0xf bank_mask:0xf
    v_add_f32_dpp v110, v110, v110 row_ror:4 row_mask:0xf bank_mask:0xf
    v_mfma_f32_16x16x32_bf16 v[96:99], a[168:171], v[52:55], v[96:99]
    s_waitcnt vmcnt(12)
    v_add_f32_dpp v111, v111, v111 row_ror:4 row_mask:0xf bank_mask:0xf
    v_add_f32_dpp v112, v112, v112 row_ror:4 row_mask:0xf bank_mask:0xf
    v_mfma_f32_16x16x32_bf16 v[100:103], a[160:163], v[48:51], v[100:103]
    v_add_f32_dpp v113, v113, v113 row_ror:4 row_mask:0xf bank_mask:0xf
    v_add_f32_dpp v114, v114, v114 row_ror:4 row_mask:0xf bank_mask:0xf
    v_mfma_f32_16x16x32_bf16 v[100:103], a[172:175], v[52:55], v[100:103]
    s_waitcnt lgkmcnt(2)
    v_add_f32_dpp v115, v115, v115 row_ror:4 row_mask:0xf bank_mask:0xf
    v_add_f32_dpp v116, v116, v116 row_ror:4 row_mask:0xf bank_mask:0xf
    v_mfma_f32_16x16x32_bf16 v[80:83], a[176:179], v[24:27], v[80:83]
    buffer_load_dwordx4 v[240:243], v6, s[32:35], s66 offen offset:0 sc1
    v_mfma_f32_16x16x32_bf16 v[80:83], a[188:191], v[28:31], v[80:83]
    s_add_u32 s66, s65, 15360
    ds_read2st64_b64 v[40:43], v8 offset0:24 offset1:26
    v_add_f32_dpp v117, v117, v117 row_ror:4 row_mask:0xf bank_mask:0xf
    v_mfma_f32_16x16x32_bf16 v[84:87], a[180:183], v[24:27], v[84:87]
    buffer_load_dwordx4 v[244:247], v4, s[32:35], s66 offen offset:0 sc1
    v_mfma_f32_16x16x32_bf16 v[84:87], a[192:195], v[28:31], v[84:87]
    ds_read2st64_b64 v[44:47], v22 offset0:28 offset1:30
    v_add_f32_dpp v118, v118, v118 row_ror:4 row_mask:0xf bank_mask:0xf
    v_mfma_f32_16x16x32_bf16 v[88:91], a[184:187], v[24:27], v[88:91]
    ds_read2st64_b64 v[48:51], v9 offset0:24 offset1:26
    v_add_f32_dpp v119, v119, v119 row_ror:4 row_mask:0xf bank_mask:0xf
    v_mfma_f32_16x16x32_bf16 v[88:91], a[196:199], v[28:31], v[88:91]
    s_waitcnt lgkmcnt(3)
    ds_read2st64_b64 v[52:55], v23 offset0:28 offset1:30
    v_add_f32_dpp v120, v120, v120 row_ror:4 row_mask:0xf bank_mask:0xf
    v_mfma_f32_16x16x32_bf16 v[92:95], a[176:179], v[32:35], v[92:95]
    buffer_load_dwordx4 v[248:251], v4, s[32:35], s66 offen offset:1024 sc1
    v_mfma_f32_16x16x32_bf16 v[92:95], a[188:191], v[36:39], v[92:95]
    v_add_f32_dpp v121, v121, v121 row_ror:4 row_mask:0xf bank_mask:0xf
    v_add_f32_dpp v122, v122, v122 row_ror:4 row_mask:0xf bank_mask:0xf
    v_mfma_f32_16x16x32_bf16 v[96:99], a[180:183], v[32:35], v[96:99]
    s_waitcnt vmcnt(14)
    v_add_f32_dpp v123, v123, v123 row_ror:4 row_mask:0xf bank_mask:0xf
    v_add_f32_dpp v124, v124, v124 row_ror:4 row_mask:0xf bank_mask:0xf
    v_mfma_f32_16x16x32_bf16 v[96:99], a[192:195], v[36:39], v[96:99]
    buffer_load_dwordx4 v[252:255], v4, s[32:35], s66 offen offset:2048 sc1
    v_mfma_f32_16x16x32_bf16 v[100:103], a[184:187], v[32:35], v[100:103]
    v_add_f32_dpp v125, v125, v125 row_ror:4 row_mask:0xf bank_mask:0xf
    v_add_f32_dpp v126, v126, v126 row_ror:4 row_mask:0xf bank_mask:0xf
    v_mfma_f32_16x16x32_bf16 v[100:103], a[196:199], v[36:39], v[100:103]
    s_waitcnt lgkmcnt(2) vmcnt(10)
    v_cmp_ne_u32 vcc, v2, v180
    s_nop 1
    s_cbranch_vccnz Lspin8
Lback8:
    v_mfma_f32_16x16x32_bf16 v[80:83], a[200:203], v[40:43], v[80:83]
    s_barrier
    ds_read2st64_b64 v[24:27], v8 offset0:32 offset1:34
    v_add_f32_dpp v127, v127, v127 row_ror:4 row_mask:0xf bank_mask:0xf
    v_mfma_f32_16x16x32_bf16 v[80:83], a[212:215], v[44:47], v[80:83]
    s_add_u32 m0, s0, 40960
    ds_read2st64_b64 v[28:31], v22 offset0:36 offset1:38
    v_add_f32_dpp v104, v104, v104 row_ror:8 row_mask:0xf bank_mask:0xf
    v_mfma_f32_16x16x32_bf16 v[84:87], a[204:207], v[40:43], v[84:87]
    s_add_u32 s63, s90, 8192
    ds_read2st64_b64 v[32:35], v9 offset0:32 offset1:34
    v_add_f32_dpp v105, v105, v105 row_ror:8 row_mask:0xf bank_mask:0xf
    v_mfma_f32_16x16x32_bf16 v[84:87], a[216:219], v[44:47], v[84:87]
    buffer_load_dwordx4 v10, s[32:35], s63 offen sc1 lds
    v_mfma_f32_16x16x32_bf16 v[88:91], a[208:211], v[40:43], v[88:91]
    ds_read2st64_b64 v[36:39], v23 offset0:36 offset1:38
    v_add_f32_dpp v106, v106, v106 row_ror:8 row_mask:0xf bank_mask:0xf
    v_mfma_f32_16x16x32_bf16 v[88:91], a[220:223], v[44:47], v[88:91]
    s_waitcnt lgkmcnt(4)
    v_add_f32_dpp v107, v107, v107 row_ror:8 row_mask:0xf bank_mask:0xf
    v_add_f32_dpp v108, v108, v108 row_ror:8 row_mask:0xf bank_mask:0xf
    v_mfma_f32_16x16x32_bf16 v[92:95], a[200:203], v[48:51], v[92:95]
    buffer_load_dwordx4 v11, s[32:35], s63 offen offset:1024 sc1 lds
    v_mfma_f32_16x16x32_bf16 v[92:95], a[212:215], v[52:55], v[92:95]
    s_add_u32 m0, s0, 49152
    v_add_f32_dpp v109, v109, v109 row_ror:8 row_mask:0xf bank_mask:0xf
    v_add_f32_dpp v110, v110, v110 row_ror:8 row_mask:0xf bank_mask:0xf
    v_mfma_f32_16x16x32_bf16 v[96:99], a[204:207], v[48:51], v[96:99]
    s_add_u32 s63, s90, 532480
    v_add_f32_dpp v111, v111, v111 row_ror:8 row_mask:0xf bank_mask:0xf
    v_add_f32_dpp v112, v112, v112 row_ror:8 row_mask:0xf bank_mask:0xf
    v_mfma_f32_16x16x32_bf16 v[96:99], a[216:219], v[52:55], v[96:99]
    buffer_load_dwordx4 v10, s[32:35], s63 offen sc1 lds
    v_mfma_f32_16x16x32_bf16 v[100:103], a[208:211], v[48:51], v[100:103]
    v_add_f32_dpp v113, v113, v113 row_ror:8 row_mask:0xf bank_mask:0xf
    v_add_f32_dpp v114, v114, v114 row_ror:8 row_mask:0xf bank_mask:0xf
    v_mfma_f32_16x16x32_bf16 v[100:103], a[220:223], v[52:55], v[100:103]
    s_waitcnt lgkmcnt(2)
    v_add_f32_dpp v115, v115, v115 row_ror:8 row_mask:0xf bank_mask:0xf
    v_add_f32_dpp v116, v116, v116 row_ror:8 row_mask:0xf bank_mask:0xf
    v_mfma_f32_16x16x32_bf16 v[80:83], a[224:227], v[24:27], v[80:83]
    buffer_load_dwordx4 v11, s[32:35], s63 offen offset:1024 sc1 lds
    v_mfma_f32_16x16x32_bf16 v[80:83], a[236:239], v[28:31], v[80:83]
    s_add_u32 m0, s0, 57344
    ds_read2st64_b64 v[40:43], v8 offset0:40 offset1:42
    v_add_f32_dpp v117, v117, v117 row_ror:8 row_mask:0xf bank_mask:0xf
    v_mfma_f32_16x16x32_bf16 v[84:87], a[228:231], v[24:27], v[84:87]
    s_add_u32 s63, s90, 1056768
    ds_read2st64_b64 v[44:47], v22 offset0:44 offset1:46
    v_add_f32_dpp v118, v118, v118 row_ror:8 row_mask:0xf bank_mask:0xf
    v_mfma_f32_16x16x32_bf16 v[84:87], a[0:3], v[28:31], v[84:87]
    buffer_load_dwordx4 v10, s[32:35], s63 offen sc1 lds
    v_mfma_f32_16x16x32_bf16 v[88:91], a[232:235], v[24:27], v[88:91]
    ds_read2st64_b64 v[48:51], v9 offset0:40 offset1:42
    v_add_f32_dpp v119, v119, v119 row_ror:8 row_mask:0xf bank_mask:0xf
    v_mfma_f32_16x16x32_bf16 v[88:91], a[4:7], v[28:31], v[88:91]
    s_waitcnt lgkmcnt(3)
    ds_read2st64_b64 v[52:55], v23 offset0:44 offset1:46
    v_add_f32_dpp v120, v120, v120 row_ror:8 row_mask:0xf bank_mask:0xf
    v_mfma_f32_16x16x32_bf16 v[92:95], a[224:227], v[32:35], v[92:95]
    v_add_f32_dpp v121, v121, v121 row_ror:8 row_mask:0xf bank_mask:0xf
    v_add_f32_dpp v122, v122, v122 row_ror:8 row_mask:0xf bank_mask:0xf
    v_mfma_f32_16x16x32_bf16 v[92:95], a[236:239], v[36:39], v[92:95]
    buffer_load_dwordx4 v11, s[32:35], s63 offen offset:1024 sc1 lds
    v_mfma_f32_16x16x32_bf16 v[96:99], a[228:231], v[32:35], v[96:99]
    s_add_u32 m0, s0, 65536
    v_add_f32_dpp v123, v123, v123 row_ror:8 row_mask:0xf bank_mask:0xf
    v_add_f32_dpp v124, v124, v124 row_ror:8 row_mask:0xf bank_mask:0xf
    v_mfma_f32_16x16x32_bf16 v[96:99], a[0:3], v[36:39], v[96:99]
    s_add_u32 s63, s90, 1581056
    v_add_f32_dpp v125, v125, v125 row_ror:8 row_mask:0xf bank_mask:0xf
    v_add_f32_dpp v126, v126, v126 row_ror:8 row_mask:0xf bank_mask:0xf
    v_mfma_f32_16x16x32_bf16 v[100:103], a[232:235], v[32:35], v[100:103]
    s_waitcnt vmcnt(14)
    v_add_f32_dpp v127, v127, v127 row_ror:8 row_mask:0xf bank_mask:0xf
    v_cmp_ne_u32 vcc, v2, v177
    v_cmp_ne_u32 s[16:17], v2, v179
    s_nop 1
    s_or_b64 vcc, vcc, s[16:17]
    s_cbranch_vccnz Lspin9
Lback9:
    v_mfma_f32_16x16x32_bf16 v[100:103], a[4:7], v[36:39], v[100:103]
    s_waitcnt lgkmcnt(2)
    v_mov_b32 v144, v176
    v_mov_b32 v148, v176
    v_mfma_f32_16x16x32_bf16 v[80:83], a[8:11], v[40:43], v[80:83]
    buffer_load_dwordx4 v10, s[32:35], s63 offen sc1 lds
    v_mfma_f32_16x16x32_bf16 v[80:83], a[20:23], v[44:47], v[80:83]
    ds_read2st64_b64 v[24:27], v8 offset0:48 offset1:50
    v_mov_b32 v145, v178
    v_mfma_f32_16x16x32_bf16 v[84:87], a[12:15], v[40:43], v[84:87]
    buffer_load_dwordx4 v11, s[32:35], s63 offen offset:1024 sc1 lds
    v_mfma_f32_16x16x32_bf16 v[84:87], a[24:27], v[44:47], v[84:87]
    s_add_u32 m0, s0, 73728
    ds_read2st64_b64 v[28:31], v22 offset0:52 offset1:54
    v_mov_b32 v149, v178
    v_mfma_f32_16x16x32_bf16 v[88:91], a[16:19], v[40:43], v[88:91]
    s_add_u32 s63, s90, 2105344
    ds_read2st64_b64 v[32:35], v9 offset0:48 offset1:50
    v_permlane32_swap_b32 v144, v148
    v_mfma_f32_16x16x32_bf16 v[88:91], a[28:31], v[44:47], v[88:91]
    s_waitcnt lgkmcnt(3)
    ds_read2st64_b64 v[36:39], v23 offset0:52 offset1:54
    v_permlane32_swap_b32 v145, v149
    v_mfma_f32_16x16x32_bf16 v[92:95], a[8:11], v[48:51], v[92:95]
    buffer_load_dwordx4 v10, s[32:35], s63 offen sc1 lds
    v_mfma_f32_16x16x32_bf16 v[92:95], a[20:23], v[52:55], v[92:95]
    v_mov_b32 v146, v144
    v_mov_b32 v150, v148
    v_mfma_f32_16x16x32_bf16 v[96:99], a[12:15], v[48:51], v[96:99]
    v_mov_b32 v147, v145
    v_mov_b32 v151, v149
    v_mfma_f32_16x16x32_bf16 v[96:99], a[24:27], v[52:55], v[96:99]
    buffer_load_dwordx4 v11, s[32:35], s63 offen offset:1024 sc1 lds
    v_mfma_f32_16x16x32_bf16 v[100:103], a[16:19], v[48:51], v[100:103]
    s_add_u32 m0, s0, 122880
    v_permlane16_swap_b32 v144, v146
    v_mfma_f32_16x16x32_bf16 v[100:103], a[28:31], v[52:55], v[100:103]
    s_waitcnt lgkmcnt(2)
    v_permlane16_swap_b32 v148, v150
    v_mfma_f32_16x16x32_bf16 v[80:83], a[32:35], v[24:27], v[80:83]
    s_add_u32 s63, s91, 8192
    ds_read2st64_b64 v[40:43], v8 offset0:56 offset1:58
    v_permlane16_swap_b32 v145, v147
    v_mfma_f32_16x16x32_bf16 v[80:83], a[44:47], v[28:31], v[80:83]
    buffer_load_dwordx4 v10, s[32:35], s63 offen sc1 lds
    v_mfma_f32_16x16x32_bf16 v[84:87], a[36:39], v[24:27], v[84:87]
    ds_read2st64_b64 v[44:47], v22 offset0:60 offset1:62
    v_permlane16_swap_b32 v149, v151
    v_mfma_f32_16x16x32_bf16 v[84:87], a[48:51], v[28:31], v[84:87]
    ds_read2st64_b64 v[48:51], v9 offset0:56 offset1:58
    v_fma_f32 v136, v104, v145, v116
    v_mfma_f32_16x16x32_bf16 v[88:91], a[40:43], v[24:27], v[88:91]
    ds_read2st64_b64 v[52:55], v23 offset0:60 offset1:62
    v_fma_f32 v137, v105, v145, v117
    v_mfma_f32_16x16x32_bf16 v[88:91], a[52:55], v[28:31], v[88:91]
Lh9:
LhopW1:
    s_cbranch_execz Lh13
    s_waitcnt lgkmcnt(4)
    v_fma_f32 v138, v106, v145, v118
    v_fma_f32 v139, v107, v145, v119
    v_mfma_f32_16x16x32_bf16 v[92:95], a[32:35], v[32:35], v[92:95]
    buffer_load_dwordx4 v11, s[32:35], s63 offen offset:1024 sc1 lds
    v_mfma_f32_16x16x32_bf16 v[92:95], a[44:47], v[36:39], v[92:95]
    s_add_u32 m0, s0, 131072
    v_fma_f32 v136, v56, v144, v136
    v_fma_f32 v137, v57, v144, v137
    v_mfma_f32_16x16x32_bf16 v[96:99], a[36:39], v[32:35], v[96:99]
    s_add_u32 s63, s91, 532480
    v_fma_f32 v138, v58, v144, v138
    v_fma_f32 v139, v59, v144, v139
    v_mfma_f32_16x16x32_bf16 v[96:99], a[48:51], v[36:39], v[96:99]
    buffer_load_dwordx4 v10, s[32:35], s63 offen sc1 lds
    v_mfma_f32_16x16x32_bf16 v[100:103], a[40:43], v[32:35], v[100:103]
    v_max_f32 v136, 0, v136
    v_max_f32 v137, 0, v137
    v_mfma_f32_16x16x32_bf16 v[100:103], a[52:55], v[36:39], v[100:103]
    s_waitcnt lgkmcnt(2)
    v_mul_f32 v136, v136, v138
    v_mul_f32 v137, v137, v139
    v_mfma_f32_16x16x32_bf16 v[80:83], a[56:59], v[40:43], v[80:83]
    buffer_load_dwordx4 v11, s[32:35], s63 offen offset:1024 sc1 lds
    v_mfma_f32_16x16x32_bf16 v[80:83], a[68:71], v[44:47], v[80:83]
    s_add_u32 m0, s0, 139264
    ds_read2st64_b64 v[24:27], v8 offset0:64 offset1:66
    v_cvt_pk_bf16_f32 v128, v136, v137
    v_mfma_f32_16x16x32_bf16 v[84:87], a[60:63], v[40:43], v[84:87]
    s_add_u32 s63, s91, 1056768
    ds_read2st64_b64 v[28:31], v22 offset0:68 offset1:70
    v_fma_f32 v140, v104, v147, v116
    v_mfma_f32_16x16x32_bf16 v[84:87], a[72:75], v[44:47], v[84:87]
    buffer_load_dwordx4 v10, s[32:35], s63 offen sc1 lds
    v_mfma_f32_16x16x32_bf16 v[88:91], a[64:67], v[40:43], v[88:91]
Lh10:
    s_cbranch_execz Lh14
    ds_read2st64_b64 v[32:35], v9 offset0:64 offset1:66
    v_fma_f32 v141, v105, v147, v117
    v_mfma_f32_16x16x32_bf16 v[88:91], a[76:79], v[44:47], v[88:91]
    s_waitcnt lgkmcnt(3)
    ds_read2st64_b64 v[36:39], v23 offset0:68 offset1:70
    v_fma_f32 v142, v106, v147, v118
    v_mfma_f32_16x16x32_bf16 v[92:95], a[56:59], v[48:51], v[92:95]
    v_fma_f32 v143, v107, v147, v119
    v_fma_f32 v140, v68, v146, v140
    v_mfma_f32_16x16x32_bf16 v[92:95], a[68:71], v[52:55], v[92:95]
    buffer_load_dwordx4 v11, s[32:35], s63 offen offset:1024 sc1 lds
    v_mfma_f32_16x16x32_bf16 v[96:99], a[60:63], v[48:51], v[96:99]
    s_add_u32 m0, s0, 147456
    v_fma_f32 v141, v69, v146, v141
    v_fma_f32 v142, v70, v146, v142
    v_mfma_f32_16x16x32_bf16 v[96:99], a[72:75], v[52:55], v[96:99]
    s_add_u32 s63, s91, 1581056
    v_fma_f32 v143, v71, v146, v143
    v_max_f32 v140, 0, v140
    v_mfma_f32_16x16x32_bf16 v[100:103], a[64:67], v[48:51], v[100:103]
    v_max_f32 v141, 0, v141
    v_mul_f32 v140, v140, v142
    v_mfma_f32_16x16x32_bf16 v[100:103], a[76:79], v[52:55], v[100:103]
    s_waitcnt lgkmcnt(2)
    v_mul_f32 v141, v141, v143
    v_cvt_pk_bf16_f32 v129, v140, v141
    v_mfma_f32_16x16x32_bf16 v[80:83], a[80:83], v[24:27], v[80:83]
    buffer_load_dwordx4 v10, s[32:35], s63 offen sc1 lds
    v_mfma_f32_16x16x32_bf16 v[80:83], a[92:95], v[28:31], v[80:83]
    ds_read2st64_b64 v[40:43], v8 offset0:72 offset1:74
    v_fma_f32 v136, v108, v145, v120
    v_mfma_f32_16x16x32_bf16 v[84:87], a[84:87], v[24:27], v[84:87]
    buffer_load_dwordx4 v11, s[32:35], s63 offen offset:1024 sc1 lds
    v_mfma_f32_16x16x32_bf16 v[84:87], a[96:99], v[28:31], v[84:87]
Lh11:
    s_cbranch_execz Lh15
    s_add_u32 m0, s0, 155648
    ds_read2st64_b64 v[44:47], v22 offset0:76 offset1:78
    v_fma_f32 v137, v109, v145, v121
    v_mfma_f32_16x16x32_bf16 v[88:91], a[88:91], v[24:27], v[88:91]
    s_add_u32 s63, s91, 2105344
    ds_read2st64_b64 v[48:51], v9 offset0:72 offset1:74
    v_fma_f32 v138, v110, v145, v122
    v_mfma_f32_16x16x32_bf16 v[88:91], a[100:103], v[28:31], v[88:91]
    s_waitcnt lgkmcnt(3)
    ds_read2st64_b64 v[52:55], v23 offset0:76 offset1:78
    v_fma_f32 v139, v111, v145, v123
    v_mfma_f32_16x16x32_bf16 v[92:95], a[80:83], v[32:35], v[92:95]
    buffer_load_dwordx4 v10, s[32:35], s63 offen sc1 lds
    v_mfma_f32_16x16x32_bf16 v[92:95], a[92:95], v[36:39], v[92:95]
    v_fma_f32 v136, v60, v144, v136
    v_fma_f32 v137, v61, v144, v137
    v_mfma_f32_16x16x32_bf16 v[96:99], a[84:87], v[32:35], v[96:99]
    v_add_u32 v8, 40960, v8
    v_add_u32 v22, 40960, v22
    v_mfma_f32_16x16x32_bf16 v[96:99], a[96:99], v[36:39], v[96:99]
    buffer_load_dwordx4 v11, s[32:35], s63 offen offset:1024 sc1 lds
    v_mfma_f32_16x16x32_bf16 v[100:103], a[88:91], v[32:35], v[100:103]
    v_add_u32 v9, 40960, v9
    v_add_u32 v23, 40960, v23
    v_mfma_f32_16x16x32_bf16 v[100:103], a[100:103], v[36:39], v[100:103]
    s_waitcnt lgkmcnt(2)
    v_fma_f32 v138, v62, v144, v138
    v_fma_f32 v139, v63, v144, v139
    v_mfma_f32_16x16x32_bf16 v[80:83], a[104:107], v[40:43], v[80:83]
    s_waitcnt vmcnt(10) lgkmcnt(0)
    s_barrier
    ds_read2st64_b64 v[24:27], v8 offset0:0 offset1:2
    v_mfma_f32_16x16x32_bf16 v[80:83], a[116:119], v[44:47], v[80:83]
    buffer_load_dwordx4 a[240:243], v4, s[32:35], s66 offen offset:3072 sc1
    v_mfma_f32_16x16x32_bf16 v[84:87], a[108:111], v[40:43], v[84:87]
    ds_read2st64_b64 v[28:31], v22 offset0:4 offset1:6
    v_max_f32 v136, 0, v136
    v_mfma_f32_16x16x32_bf16 v[84:87], a[120:123], v[44:47], v[84:87]
    ds_read2st64_b64 v[32:35], v9 offset0:0 offset1:2
    v_max_f32 v137, 0, v137
    v_mfma_f32_16x16x32_bf16 v[88:91], a[112:115], v[40:43], v[88:91]
    ds_read2st64_b64 v[36:39], v23 offset0:4 offset1:6
    v_mul_f32 v136, v136, v138
    v_mfma_f32_16x16x32_bf16 v[88:91], a[124:127], v[44:47], v[88:91]
    v_mul_f32 v137, v137, v139
    v_cvt_pk_bf16_f32 v130, v136, v137
    v_mfma_f32_16x16x32_bf16 v[92:95], a[104:107], v[48:51], v[92:95]
    buffer_load_dwordx4 a[244:247], v6, s[32:35], s66 offen offset:0 sc1
    v_mfma_f32_16x16x32_bf16 v[92:95], a[116:119], v[52:55], v[92:95]
    s_add_u32 s66, s65, 20480
    v_fma_f32 v140, v108, v147, v120
    v_fma_f32 v141, v109, v147, v121
    v_mfma_f32_16x16x32_bf16 v[96:99], a[108:111], v[48:51], v[96:99]
    buffer_load_dwordx4 a[248:251], v4, s[32:35], s66 offen offset:0 sc1
    v_mfma_f32_16x16x32_bf16 v[96:99], a[120:123], v[52:55], v[96:99]
    v_fma_f32 v142, v110, v147, v122
    v_fma_f32 v143, v111, v147, v123
    v_mfma_f32_16x16x32_bf16 v[100:103], a[112:115], v[48:51], v[100:103]
    v_fma_f32 v140, v72, v146, v140
    v_fma_f32 v141, v73, v146, v141
    v_mfma_f32_16x16x32_bf16 v[100:103], a[124:127], v[52:55], v[100:103]
    s_waitcnt lgkmcnt(2)
    v_fma_f32 v142, v74, v146, v142
    v_fma_f32 v143, v75, v146, v143
    v_max_f32 v140, 0, v140
    v_max_f32 v141, 0, v141
    v_mul_f32 v140, v140, v142
    v_mul_f32 v141, v141, v143
    v_cvt_pk_bf16_f32 v131, v140, v141
    v_permlane32_swap_b32 v128, v129
    v_fma_f32 v136, v112, v145, v124
    v_fma_f32 v137, v113, v145, v125
    v_fma_f32 v138, v114, v145, v126
    v_fma_f32 v139, v115, v145, v127
    v_fma_f32 v136, v64, v144, v136
    v_fma_f32 v137, v65, v144, v137
    v_fma_f32 v138, v66, v144, v138
    v_fma_f32 v139, v67, v144, v139
    v_max_f32 v136, 0, v136
    v_max_f32 v137, 0, v137
    v_mul_f32 v136, v136, v138
    v_mul_f32 v137, v137, v139
    v_cvt_pk_bf16_f32 v132, v136, v137
    v_fma_f32 v140, v112, v147, v124
    v_fma_f32 v141, v113, v147, v125
    v_fma_f32 v142, v114, v147, v126
    v_fma_f32 v143, v115, v147, v127
    v_fma_f32 v140, v76, v146, v140
    v_fma_f32 v141, v77, v146, v141
    v_fma_f32 v142, v78, v146, v142
    v_fma_f32 v143, v79, v146, v143
    v_max_f32 v140, 0, v140
    v_max_f32 v141, 0, v141
    v_mul_f32 v140, v140, v142
    v_mul_f32 v141, v141, v143
    v_cvt_pk_bf16_f32 v134, v140, v141
    v_permlane32_swap_b32 v130, v131
    s_add_u32 s51, s94, 0
    v_permlane32_swap_b32 v132, v134
    buffer_store_dwordx4 v[128:131], v12, s[32:35], s51 offen sc1
    s_nop 0
    v_permlane16_swap_b32 v132, v133
    v_permlane16_swap_b32 v134, v135
    buffer_store_dwordx4 v[132:135], v13, s[32:35], s51 offen offset:512 sc1
    v_mfma_f32_16x16x32_bf16 v[56:59], a[128:131], v[24:27], 0
    buffer_load_dwordx4 a[252:255], v4, s[32:35], s66 offen offset:1024 sc1
    v_mfma_f32_16x16x32_bf16 v[56:59], a[140:143], v[28:31], v[56:59]
    s_add_u32 m0, s96, 81920
    ds_read2st64_b64 v[40:43], v8 offset0:8 offset1:10
    v_subrev_u32 v19, 81920, v19
    v_mfma_f32_16x16x32_bf16 v[60:63], a[132:135], v[24:27], 0
    s_add_u32 s66, s65, 40960
    ds_read2st64_b64 v[44:47], v22 offset0:12 offset1:14
    v_lshrrev_b32 v170, 5, v1
    v_mfma_f32_16x16x32_bf16 v[60:63], a[144:147], v[28:31], v[60:63]
    buffer_load_dwordx4 v4, s[32:35], s66 offen offset:0 sc1 lds
    v_mfma_f32_16x16x32_bf16 v[64:67], a[136:139], v[24:27], 0
    ds_read2st64_b64 v[48:51], v9 offset0:8 offset1:10
    v_lshlrev_b32 v170, 14, v170
    v_mfma_f32_16x16x32_bf16 v[64:67], a[148:151], v[28:31], v[64:67]
    s_waitcnt lgkmcnt(3)
    ds_read2st64_b64 v[52:55], v23 offset0:12 offset1:14
    v_sub_u32 v170, v19, v170
    v_mfma_f32_16x16x32_bf16 v[68:71], a[128:131], v[32:35], 0
    ds_read_b64 v[164:165], v19
    v_mfma_f32_16x16x32_bf16 v[68:71], a[140:143], v[36:39], v[68:71]
    buffer_load_dwordx4 v4, s[32:35], s66 offen offset:1024 sc1 lds
    v_mfma_f32_16x16x32_bf16 v[72:75], a[132:135], v[32:35], 0
    ds_read_b64 v[166:167], v19 offset:16384
    v_mfma_f32_16x16x32_bf16 v[72:75], a[144:147], v[36:39], v[72:75]
    ds_read_b64 v[168:169], v170 offset:32768
    v_mfma_f32_16x16x32_bf16 v[76:79], a[136:139], v[32:35], 0
    v_mfma_f32_16x16x32_bf16 v[76:79], a[148:151], v[36:39], v[76:79]
    s_waitcnt lgkmcnt(5)
    v_mfma_f32_16x16x32_bf16 v[56:59], a[152:155], v[40:43], v[56:59]
    s_waitcnt lgkmcnt(2)
    buffer_load_dwordx4 v4, s[32:35], s66 offen offset:2048 sc1 lds
    v_lshlrev_b32 v128, 16, v164
    v_mfma_f32_16x16x32_bf16 v[56:59], a[164:167], v[44:47], v[56:59]
    ds_read2st64_b64 v[24:27], v8 offset0:16 offset1:18
    v_and_b32 v129, 0xffff0000, v164
    v_lshlrev_b32 v130, 16, v165
    v_mfma_f32_16x16x32_bf16 v[60:63], a[156:159], v[40:43], v[60:63]
    buffer_load_dwordx4 v4, s[32:35], s66 offen offset:3072 sc1 lds
    v_and_b32 v131, 0xffff0000, v165
    v_mfma_f32_16x16x32_bf16 v[60:63], a[168:171], v[44:47], v[60:63]
    s_waitcnt lgkmcnt(2)
    s_add_u32 m0, s96, 86016
    ds_read2st64_b64 v[28:31], v22 offset0:20 offset1:22
    v_lshlrev_b32 v132, 16, v166
    v_and_b32 v133, 0xffff0000, v166
    v_mfma_f32_16x16x32_bf16 v[64:67], a[160:163], v[40:43], v[64:67]
    ds_read2st64_b64 v[32:35], v9 offset0:16 offset1:18
    v_lshlrev_b32 v134, 16, v167
    v_and_b32 v135, 0xffff0000, v167
    v_mfma_f32_16x16x32_bf16 v[64:67], a[172:175], v[44:47], v[64:67]
    s_waitcnt lgkmcnt(3)
    ds_read2st64_b64 v[36:39], v23 offset0:20 offset1:22
    v_lshlrev_b32 v136, 16, v168
    v_and_b32 v137, 0xffff0000, v168
    v_mfma_f32_16x16x32_bf16 v[68:71], a[152:155], v[48:51], v[68:71]
    buffer_load_dwordx4 v6, s[32:35], s66 offen sc1 lds
    v_lshlrev_b32 v138, 16, v169
    v_mfma_f32_16x16x32_bf16 v[68:71], a[164:167], v[52:55], v[68:71]
    s_add_u32 m0, s96, 87040
    v_and_b32 v139, 0xffff0000, v169
    v_pk_mul_f32 v[128:129], v[128:129], v[152:153]
    v_pk_mul_f32 v[130:131], v[130:131], v[154:155]
    v_pk_mul_f32 v[132:133], v[132:133], v[156:157]
    v_pk_mul_f32 v[134:135], v[134:135], v[158:159]
    v_pk_mul_f32 v[136:137], v[136:137], v[160:161]
    v_pk_mul_f32 v[138:139], v[138:139], v[162:163]
    v_pk_add_f32 v[170:171], v[128:129], v[130:131]
    v_pk_mul_f32 v[172:173], v[128:129], v[128:129]
    v_pk_fma_f32 v[172:173], v[130:131], v[130:131], v[172:173]
    v_pk_add_f32 v[170:171], v[170:171], v[132:133]
    v_pk_fma_f32 v[172:173], v[132:133], v[132:133], v[172:173]
    v_pk_add_f32 v[170:171], v[170:171], v[134:135]
    v_pk_fma_f32 v[172:173], v[134:135], v[134:135], v[172:173]
    v_pk_add_f32 v[170:171], v[170:171], v[136:137]
    v_pk_fma_f32 v[172:173], v[136:137], v[136:137], v[172:173]
    v_pk_add_f32 v[170:171], v[170:171], v[138:139]
    v_pk_fma_f32 v[172:173], v[138:139], v[138:139], v[172:173]
    v_add_f32 v174, v170, v171
    v_mfma_f32_16x16x32_bf16 v[72:75], a[156:159], v[48:51], v[72:75]
    s_add_u32 s66, s65, 46080
    v_add_f32 v175, v172, v173
    v_add_f32_dpp v174, v174, v174 row_ror:8 row_mask:0xf bank_mask:0xf
    s_nop 0
    v_add_f32_dpp v175, v175, v175 row_ror:8 row_mask:0xf bank_mask:0xf
    v_mfma_f32_16x16x32_bf16 v[72:75], a[168:171], v[52:55], v[72:75]
    buffer_load_dwordx4 v4, s[32:35], s66 offen offset:0 sc1 lds
    v_add_f32_dpp v174, v174, v174 row_ror:4 row_mask:0xf bank_mask:0xf
    v_mfma_f32_16x16x32_bf16 v[76:79], a[160:163], v[48:51], v[76:79]
    v_add_f32_dpp v175, v175, v175 row_ror:4 row_mask:0xf bank_mask:0xf
    v_add_f32_dpp v174, v174, v174 row_ror:2 row_mask:0xf bank_mask:0xf
    s_nop 0
    v_add_f32_dpp v175, v175, v175 row_ror:2 row_mask:0xf bank_mask:0xf
    v_mfma_f32_16x16x32_bf16 v[76:79], a[172:175], v[52:55], v[76:79]
    s_waitcnt lgkmcnt(2)
    v_add_f32_dpp v174, v174, v174 row_ror:1 row_mask:0xf bank_mask:0xf
    v_add_f32_dpp v175, v175, v175 row_ror:1 row_mask:0xf bank_mask:0xf
    s_nop 0
    v_add_f32_dpp v174, v174, v174 row_bcast:15 row_mask:0xa bank_mask:0xf
    v_mfma_f32_16x16x32_bf16 v[56:59], a[176:179], v[24:27], v[56:59]
    ds_read2st64_b64 v[40:43], v8 offset0:24 offset1:26
    v_add_f32_dpp v175, v175, v175 row_bcast:15 row_mask:0xa bank_mask:0xf
    v_add_f32_dpp v174, v174, v174 row_bcast:31 row_mask:0xc bank_mask:0xf
    v_mfma_f32_16x16x32_bf16 v[56:59], a[188:191], v[28:31], v[56:59]
    buffer_load_dwordx4 v4, s[32:35], s66 offen offset:1024 sc1 lds
    v_add_f32_dpp v175, v175, v175 row_bcast:31 row_mask:0xc bank_mask:0xf
    v_mfma_f32_16x16x32_bf16 v[60:63], a[180:183], v[24:27], v[60:63]
    ds_read2st64_b64 v[44:47], v22 offset0:28 offset1:30
    v_mul_f32 v174, 0x3acccccd, v174
    v_mul_f32 v175, 0x3acccccd, v175
    v_mfma_f32_16x16x32_bf16 v[60:63], a[192:195], v[28:31], v[60:63]
    ds_read2st64_b64 v[48:51], v9 offset0:24 offset1:26
    v_mov_b32 v165, v2
    v_fma_f32 v175, -v174, v174, v175
    v_mfma_f32_16x16x32_bf16 v[64:67], a[184:187], v[24:27], v[64:67]
    ds_read2st64_b64 v[52:55], v23 offset0:28 offset1:30
    v_max_f32 v175, 0, v175
    v_add_f32 v175, 0x3727c5ac, v175
    v_mfma_f32_16x16x32_bf16 v[64:67], a[196:199], v[28:31], v[64:67]
    s_waitcnt lgkmcnt(4)
    v_rsq_f32 v164, v175
    v_mov_b32 v167, v2
    v_mfma_f32_16x16x32_bf16 v[68:71], a[176:179], v[32:35], v[68:71]
    buffer_load_dwordx4 v4, s[32:35], s66 offen offset:2048 sc1 lds
    v_mul_f32_e64 v166, -v174, v164
    v_mfma_f32_16x16x32_bf16 v[68:71], a[188:191], v[36:39], v[68:71]
    s_add_u32 s53, s70, 32768
    v_fma_f32 v136, v104, v149, v116
    v_fma_f32 v137, v105, v149, v117
    v_mfma_f32_16x16x32_bf16 v[72:75], a[180:183], v[32:35], v[72:75]
    buffer_load_dwordx4 v4, s[32:35], s66 offen offset:3072 sc1 lds
    v_mfma_f32_16x16x32_bf16 v[72:75], a[192:195], v[36:39], v[72:75]
    buffer_store_dwordx4 v[164:167], v20, s[32:35], s53 offen sc1
    v_mfma_f32_16x16x32_bf16 v[76:79], a[184:187], v[32:35], v[76:79]
    s_add_u32 m0, s96, 91136
    v_fma_f32 v138, v106, v149, v118
    v_fma_f32 v139, v107, v149, v119
    v_mfma_f32_16x16x32_bf16 v[76:79], a[196:199], v[36:39], v[76:79]
    s_waitcnt lgkmcnt(2)
    v_fma_f32 v136, v80, v148, v136
    v_fma_f32 v137, v81, v148, v137
    v_mfma_f32_16x16x32_bf16 v[56:59], a[200:203], v[40:43], v[56:59]
    ds_read2st64_b64 v[24:27], v8 offset0:32 offset1:34
    v_fma_f32 v138, v82, v148, v138
    v_mfma_f32_16x16x32_bf16 v[56:59], a[212:215], v[44:47], v[56:59]
    ds_read2st64_b64 v[28:31], v22 offset0:36 offset1:38
    v_fma_f32 v139, v83, v148, v139
    v_mfma_f32_16x16x32_bf16 v[60:63], a[204:207], v[40:43], v[60:63]
    ds_read2st64_b64 v[32:35], v9 offset0:32 offset1:34
    v_max_f32 v136, 0, v136
    v_mfma_f32_16x16x32_bf16 v[60:63], a[216:219], v[44:47], v[60:63]
    buffer_load_dwordx4 v6, s[32:35], s66 offen sc1 lds
    v_mfma_f32_16x16x32_bf16 v[64:67], a[208:211], v[40:43], v[64:67]
    s_add_u32 m0, s96, 0
    ds_read2st64_b64 v[36:39], v23 offset0:36 offset1:38
    v_max_f32 v137, 0, v137
    v_mfma_f32_16x16x32_bf16 v[64:67], a[220:223], v[44:47], v[64:67]
    s_waitcnt lgkmcnt(4)
    v_mul_f32 v136, v136, v138
    v_mul_f32 v137, v137, v139
    v_mfma_f32_16x16x32_bf16 v[68:71], a[200:203], v[48:51], v[68:71]
    s_add_u32 s66, s65, 51200
    v_cvt_pk_bf16_f32 v128, v136, v137
    v_fma_f32 v140, v104, v151, v116
    v_mfma_f32_16x16x32_bf16 v[68:71], a[212:215], v[52:55], v[68:71]
    buffer_load_dwordx4 v4, s[32:35], s66 offen offset:0 sc1 lds
    v_mfma_f32_16x16x32_bf16 v[72:75], a[204:207], v[48:51], v[72:75]
    v_fma_f32 v141, v105, v151, v117
    v_fma_f32 v142, v106, v151, v118
    v_mfma_f32_16x16x32_bf16 v[72:75], a[216:219], v[52:55], v[72:75]
    v_fma_f32 v143, v107, v151, v119
    v_fma_f32 v140, v92, v150, v140
    v_mfma_f32_16x16x32_bf16 v[76:79], a[208:211], v[48:51], v[76:79]
    v_fma_f32 v141, v93, v150, v141
    v_fma_f32 v142, v94, v150, v142
    v_mfma_f32_16x16x32_bf16 v[76:79], a[220:223], v[52:55], v[76:79]
    s_waitcnt lgkmcnt(2)
    v_fma_f32 v143, v95, v150, v143
    v_max_f32 v140, 0, v140
    v_mfma_f32_16x16x32_bf16 v[56:59], a[224:227], v[24:27], v[56:59]
    buffer_load_dwordx4 v4, s[32:35], s66 offen offset:1024 sc1 lds
    v_mfma_f32_16x16x32_bf16 v[56:59], a[236:239], v[28:31], v[56:59]
    ds_read2st64_b64 v[40:43], v8 offset0:40 offset1:42
    v_max_f32 v141, 0, v141
    v_mfma_f32_16x16x32_bf16 v[60:63], a[228:231], v[24:27], v[60:63]
    buffer_load_dwordx4 v4, s[32:35], s66 offen offset:2048 sc1 lds
    v_mfma_f32_16x16x32_bf16 v[60:63], a[0:3], v[28:31], v[60:63]
    ds_read2st64_b64 v[44:47], v22 offset0:44 offset1:46
    v_mul_f32 v140, v140, v142
    v_mfma_f32_16x16x32_bf16 v[64:67], a[232:235], v[24:27], v[64:67]
    ds_read2st64_b64 v[48:51], v9 offset0:40 offset1:42
    v_mul_f32 v141, v141, v143
    v_mfma_f32_16x16x32_bf16 v[64:67], a[4:7], v[28:31], v[64:67]
    s_waitcnt lgkmcnt(3)
    ds_read2st64_b64 v[52:55], v23 offset0:44 offset1:46
    v_cvt_pk_bf16_f32 v129, v140, v141
    v_mfma_f32_16x16x32_bf16 v[68:71], a[224:227], v[32:35], v[68:71]
    buffer_load_dwordx4 v4, s[32:35], s66 offen offset:3072 sc1 lds
    v_mfma_f32_16x16x32_bf16 v[68:71], a[236:239], v[36:39], v[68:71]
    s_add_u32 m0, s96, 4096
    v_fma_f32 v136, v108, v149, v120
    v_fma_f32 v137, v109, v149, v121
    v_mfma_f32_16x16x32_bf16 v[72:75], a[228:231], v[32:35], v[72:75]
    v_fma_f32 v138, v110, v149, v122
    v_fma_f32 v139, v111, v149, v123
    v_mfma_f32_16x16x32_bf16 v[72:75], a[0:3], v[36:39], v[72:75]
    buffer_load_dwordx4 v6, s[32:35], s66 offen sc1 lds
    v_mfma_f32_16x16x32_bf16 v[76:79], a[232:235], v[32:35], v[76:79]
    s_add_u32 m0, s96, 5120
    v_fma_f32 v136, v84, v148, v136
    v_fma_f32 v137, v85, v148, v137
    v_mfma_f32_16x16x32_bf16 v[76:79], a[4:7], v[36:39], v[76:79]
    s_waitcnt lgkmcnt(2)
    v_fma_f32 v138, v86, v148, v138
    v_fma_f32 v139, v87, v148, v139
    v_mfma_f32_16x16x32_bf16 v[56:59], a[8:11], v[40:43], v[56:59]
    s_add_u32 s66, s65, 56320
    ds_read2st64_b64 v[24:27], v8 offset0:48 offset1:50
    v_max_f32 v136, 0, v136
    v_mfma_f32_16x16x32_bf16 v[56:59], a[20:23], v[44:47], v[56:59]
    buffer_load_dwordx4 v4, s[32:35], s66 offen offset:0 sc1 lds
    v_mfma_f32_16x16x32_bf16 v[60:63], a[12:15], v[40:43], v[60:63]
    ds_read2st64_b64 v[28:31], v22 offset0:52 offset1:54
    v_max_f32 v137, 0, v137
    v_mfma_f32_16x16x32_bf16 v[60:63], a[24:27], v[44:47], v[60:63]
    ds_read2st64_b64 v[32:35], v9 offset0:48 offset1:50
    v_mul_f32 v136, v136, v138
    v_mfma_f32_16x16x32_bf16 v[64:67], a[16:19], v[40:43], v[64:67]
    ds_read2st64_b64 v[36:39], v23 offset0:52 offset1:54
    v_mul_f32 v137, v137, v139
    v_mfma_f32_16x16x32_bf16 v[64:67], a[28:31], v[44:47], v[64:67]
    s_waitcnt lgkmcnt(4)
    v_cvt_pk_bf16_f32 v130, v136, v137
    v_fma_f32 v140, v108, v151, v120
    v_mfma_f32_16x16x32_bf16 v[68:71], a[8:11], v[48:51], v[68:71]
    buffer_load_dwordx4 v4, s[32:35], s66 offen offset:1024 sc1 lds
    v_mfma_f32_16x16x32_bf16 v[68:71], a[20:23], v[52:55], v[68:71]
    v_fma_f32 v141, v109, v151, v121
    v_fma_f32 v142, v110, v151, v122
    v_mfma_f32_16x16x32_bf16 v[72:75], a[12:15], v[48:51], v[72:75]
    buffer_load_dwordx4 v4, s[32:35], s66 offen offset:2048 sc1 lds
    v_mfma_f32_16x16x32_bf16 v[72:75], a[24:27], v[52:55], v[72:75]
    v_fma_f32 v143, v111, v151, v123
    v_fma_f32 v140, v96, v150, v140
    v_mfma_f32_16x16x32_bf16 v[76:79], a[16:19], v[48:51], v[76:79]
    v_fma_f32 v141, v97, v150, v141
    v_fma_f32 v142, v98, v150, v142
    v_mfma_f32_16x16x32_bf16 v[76:79], a[28:31], v[52:55], v[76:79]
    s_waitcnt lgkmcnt(2)
    v_fma_f32 v143, v99, v150, v143
    v_max_f32 v140, 0, v140
    v_mfma_f32_16x16x32_bf16 v[56:59], a[32:35], v[24:27], v[56:59]
    buffer_load_dwordx4 v4, s[32:35], s66 offen offset:3072 sc1 lds
    v_mfma_f32_16x16x32_bf16 v[56:59], a[44:47], v[28:31], v[56:59]
    s_add_u32 m0, s96, 9216
    ds_read2st64_b64 v[40:43], v8 offset0:56 offset1:58
    v_max_f32 v141, 0, v141
    v_mfma_f32_16x16x32_bf16 v[60:63], a[36:39], v[24:27], v[60:63]
    ds_read2st64_b64 v[44:47], v22 offset0:60 offset1:62
    v_mul_f32 v140, v140, v142
    v_mfma_f32_16x16x32_bf16 v[60:63], a[48:51], v[28:31], v[60:63]
    buffer_load_dwordx4 v6, s[32:35], s66 offen sc1 lds
    v_mfma_f32_16x16x32_bf16 v[64:67], a[40:43], v[24:27], v[64:67]
    s_add_u32 s66, s65, 20480
    ds_read2st64_b64 v[48:51], v9 offset0:56 offset1:58
    v_mul_f32 v141, v141, v143
    v_mfma_f32_16x16x32_bf16 v[64:67], a[52:55], v[28:31], v[64:67]
    s_waitcnt lgkmcnt(3)
    ds_read2st64_b64 v[52:55], v23 offset0:60 offset1:62
    v_cvt_pk_bf16_f32 v131, v140, v141
    v_mfma_f32_16x16x32_bf16 v[68:71], a[32:35], v[32:35], v[68:71]
    v_permlane32_swap_b32 v128, v129
    v_mfma_f32_16x16x32_bf16 v[68:71], a[44:47], v[36:39], v[68:71]
    v_fma_f32 v136, v112, v149, v124
    v_fma_f32 v137, v113, v149, v125
    v_mfma_f32_16x16x32_bf16 v[72:75], a[36:39], v[32:35], v[72:75]
    v_fma_f32 v138, v114, v149, v126
    v_fma_f32 v139, v115, v149, v127
    v_mfma_f32_16x16x32_bf16 v[72:75], a[48:51], v[36:39], v[72:75]
    v_fma_f32 v136, v88, v148, v136
    v_fma_f32 v137, v89, v148, v137
    v_mfma_f32_16x16x32_bf16 v[76:79], a[40:43], v[32:35], v[76:79]
    v_fma_f32 v138, v90, v148, v138
    v_fma_f32 v139, v91, v148, v139
    v_mfma_f32_16x16x32_bf16 v[76:79], a[52:55], v[36:39], v[76:79]
    s_waitcnt lgkmcnt(2)
    v_max_f32 v136, 0, v136
    v_max_f32 v137, 0, v137
    v_mfma_f32_16x16x32_bf16 v[56:59], a[56:59], v[40:43], v[56:59]
    ds_read2st64_b64 v[24:27], v8 offset0:64 offset1:66
    v_mul_f32 v136, v136, v138
    v_mfma_f32_16x16x32_bf16 v[56:59], a[68:71], v[44:47], v[56:59]
    ds_read2st64_b64 v[28:31], v22 offset0:68 offset1:70
    v_mul_f32 v137, v137, v139
    v_mfma_f32_16x16x32_bf16 v[60:63], a[60:63], v[40:43], v[60:63]
    ds_read2st64_b64 v[32:35], v9 offset0:64 offset1:66
    v_cvt_pk_bf16_f32 v132, v136, v137
    v_mfma_f32_16x16x32_bf16 v[60:63], a[72:75], v[44:47], v[60:63]
    ds_read2st64_b64 v[36:39], v23 offset0:68 offset1:70
    v_fma_f32 v140, v112, v151, v124
    v_mfma_f32_16x16x32_bf16 v[64:67], a[64:67], v[40:43], v[64:67]
    v_fma_f32 v141, v113, v151, v125
    v_fma_f32 v142, v114, v151, v126
    v_mfma_f32_16x16x32_bf16 v[64:67], a[76:79], v[44:47], v[64:67]
    s_waitcnt lgkmcnt(4)
    v_fma_f32 v143, v115, v151, v127
    v_fma_f32 v140, v100, v150, v140
    v_mfma_f32_16x16x32_bf16 v[68:71], a[56:59], v[48:51], v[68:71]
    v_fma_f32 v141, v101, v150, v141
    v_fma_f32 v142, v102, v150, v142
    v_mfma_f32_16x16x32_bf16 v[68:71], a[68:71], v[52:55], v[68:71]
    v_fma_f32 v143, v103, v150, v143
    v_max_f32 v140, 0, v140
    v_mfma_f32_16x16x32_bf16 v[72:75], a[60:63], v[48:51], v[72:75]
    v_max_f32 v141, 0, v141
    v_mul_f32 v140, v140, v142
    v_mfma_f32_16x16x32_bf16 v[72:75], a[72:75], v[52:55], v[72:75]
    v_mul_f32 v141, v141, v143
    v_cvt_pk_bf16_f32 v134, v140, v141
    v_mfma_f32_16x16x32_bf16 v[76:79], a[64:67], v[48:51], v[76:79]
    v_permlane32_swap_b32 v130, v131
    v_mfma_f32_16x16x32_bf16 v[76:79], a[76:79], v[52:55], v[76:79]
    s_waitcnt lgkmcnt(2)
    s_add_u32 s51, s95, 0
    v_permlane32_swap_b32 v132, v134
    v_mfma_f32_16x16x32_bf16 v[56:59], a[80:83], v[24:27], v[56:59]
    buffer_store_dwordx4 v[128:131], v12, s[32:35], s51 offen sc1
    v_mfma_f32_16x16x32_bf16 v[56:59], a[92:95], v[28:31], v[56:59]
    ds_read2st64_b64 v[40:43], v8 offset0:72 offset1:74
    v_permlane16_swap_b32 v132, v133
    v_mfma_f32_16x16x32_bf16 v[60:63], a[84:87], v[24:27], v[60:63]
    ds_read2st64_b64 v[44:47], v22 offset0:76 offset1:78
    v_permlane16_swap_b32 v134, v135
    v_mfma_f32_16x16x32_bf16 v[60:63], a[96:99], v[28:31], v[60:63]
    buffer_store_dwordx4 v[132:135], v13, s[32:35], s51 offen offset:512 sc1
    v_mfma_f32_16x16x32_bf16 v[64:67], a[88:91], v[24:27], v[64:67]
    ds_read2st64_b64 v[48:51], v9 offset0:72 offset1:74
    v_mfma_f32_16x16x32_bf16 v[64:67], a[100:103], v[28:31], v[64:67]
    s_waitcnt lgkmcnt(3)
    ds_read2st64_b64 v[52:55], v23 offset0:76 offset1:78
    v_mfma_f32_16x16x32_bf16 v[68:71], a[80:83], v[32:35], v[68:71]
    v_mfma_f32_16x16x32_bf16 v[68:71], a[92:95], v[36:39], v[68:71]
    v_mfma_f32_16x16x32_bf16 v[72:75], a[84:87], v[32:35], v[72:75]
    v_add_u32 v8, 81920, v8
    v_add_u32 v22, 81920, v22
    v_mfma_f32_16x16x32_bf16 v[72:75], a[96:99], v[36:39], v[72:75]
    v_add_u32 v9, 81920, v9
    v_add_u32 v23, 81920, v23
    v_mfma_f32_16x16x32_bf16 v[76:79], a[88:91], v[32:35], v[76:79]
    v_mfma_f32_16x16x32_bf16 v[76:79], a[100:103], v[36:39], v[76:79]
    s_waitcnt lgkmcnt(2) vmcnt(24)
    s_barrier
    v_mfma_f32_16x16x32_bf16 v[56:59], a[104:107], v[40:43], v[56:59]
    s_lshl_b32 s52, s3, 7
    ds_read2st64_b64 v[24:27], v8 offset0:0 offset1:2
    s_add_u32 s52, s52, 22126592
    v_mfma_f32_16x16x32_bf16 v[56:59], a[116:119], v[44:47], v[56:59]
    buffer_store_dword v2, v3, s[32:35], s52 offen sc1
    v_mfma_f32_16x16x32_bf16 v[60:63], a[108:111], v[40:43], v[60:63]
    ds_read2st64_b64 v[28:31], v22 offset0:4 offset1:6
    v_mfma_f32_16x16x32_bf16 v[60:63], a[120:123], v[44:47], v[60:63]
    ds_read2st64_b64 v[32:35], v9 offset0:0 offset1:2
    v_mfma_f32_16x16x32_bf16 v[64:67], a[112:115], v[40:43], v[64:67]
    ds_read2st64_b64 v[36:39], v23 offset0:4 offset1:6
    v_mfma_f32_16x16x32_bf16 v[64:67], a[124:127], v[44:47], v[64:67]
    s_waitcnt lgkmcnt(4)
    v_mfma_f32_16x16x32_bf16 v[68:71], a[104:107], v[48:51], v[68:71]
    v_mfma_f32_16x16x32_bf16 v[68:71], a[116:119], v[52:55], v[68:71]
    v_mfma_f32_16x16x32_bf16 v[72:75], a[108:111], v[48:51], v[72:75]
    v_mfma_f32_16x16x32_bf16 v[72:75], a[120:123], v[52:55], v[72:75]
    v_mfma_f32_16x16x32_bf16 v[76:79], a[112:115], v[48:51], v[76:79]
    s_add_u32 s8, s70, 32768
    v_mfma_f32_16x16x32_bf16 v[76:79], a[124:127], v[52:55], v[76:79]
    s_waitcnt lgkmcnt(2)
    v_mfma_f32_16x16x32_bf16 v[80:83], a[128:131], v[24:27], 0
    buffer_load_dwordx4 v[176:179], v21, s[32:35], s8 offen sc1
    v_mfma_f32_16x16x32_bf16 v[80:83], a[140:143], v[28:31], v[80:83]
    ds_read2st64_b64 v[40:43], v8 offset0:8 offset1:10
    v_add_u32 v11, s96, v4
    v_mfma_f32_16x16x32_bf16 v[84:87], a[132:135], v[24:27], 0
    ds_read2st64_b64 v[44:47], v22 offset0:12 offset1:14
    v_add_u32 v10, 81920, v11
    v_mfma_f32_16x16x32_bf16 v[84:87], a[144:147], v[28:31], v[84:87]
    ds_read2st64_b64 v[48:51], v9 offset0:8 offset1:10
    v_mfma_f32_16x16x32_bf16 v[88:91], a[136:139], v[24:27], 0
    ds_read2st64_b64 v[52:55], v23 offset0:12 offset1:14
    v_mfma_f32_16x16x32_bf16 v[88:91], a[148:151], v[28:31], v[88:91]
    s_waitcnt lgkmcnt(4)
    v_mfma_f32_16x16x32_bf16 v[92:95], a[128:131], v[32:35], 0
    v_mfma_f32_16x16x32_bf16 v[92:95], a[140:143], v[36:39], v[92:95]
    v_mfma_f32_16x16x32_bf16 v[96:99], a[132:135], v[32:35], 0
    v_mfma_f32_16x16x32_bf16 v[96:99], a[144:147], v[36:39], v[96:99]
    v_mfma_f32_16x16x32_bf16 v[100:103], a[136:139], v[32:35], 0
    v_mfma_f32_16x16x32_bf16 v[100:103], a[148:151], v[36:39], v[100:103]
Lh12:
    s_cbranch_execz Lh16
    s_waitcnt lgkmcnt(2)
    v_mfma_f32_16x16x32_bf16 v[80:83], a[152:155], v[40:43], v[80:83]
    buffer_load_dwordx4 a[128:131], v4, s[32:35], s66 offen offset:2048 sc1
    v_mfma_f32_16x16x32_bf16 v[80:83], a[164:167], v[44:47], v[80:83]
    buffer_load_dwordx4 a[132:135], v4, s[32:35], s66 offen offset:3072 sc1
    v_mfma_f32_16x16x32_bf16 v[84:87], a[156:159], v[40:43], v[84:87]
    ds_read2st64_b64 v[24:27], v8 offset0:16 offset1:18
    v_mfma_f32_16x16x32_bf16 v[84:87], a[168:171], v[44:47], v[84:87]
    buffer_load_dwordx4 a[136:139], v6, s[32:35], s66 offen offset:0 sc1
    v_mfma_f32_16x16x32_bf16 v[88:91], a[160:163], v[40:43], v[88:91]
    s_add_u32 s66, s65, 25600
    ds_read2st64_b64 v[28:31], v22 offset0:20 offset1:22
    v_mfma_f32_16x16x32_bf16 v[88:91], a[172:175], v[44:47], v[88:91]
    s_waitcnt lgkmcnt(2)
    ds_read2st64_b64 v[32:35], v9 offset0:16 offset1:18
    v_mfma_f32_16x16x32_bf16 v[92:95], a[152:155], v[48:51], v[92:95]
    ds_read2st64_b64 v[36:39], v23 offset0:20 offset1:22
    v_mfma_f32_16x16x32_bf16 v[92:95], a[164:167], v[52:55], v[92:95]
    buffer_load_dwordx4 a[140:143], v4, s[32:35], s66 offen offset:0 sc1
    v_mfma_f32_16x16x32_bf16 v[96:99], a[156:159], v[48:51], v[96:99]
    s_waitcnt vmcnt(6)
    s_barrier
    s_lshl_b32 s52, s3, 7
    v_mfma_f32_16x16x32_bf16 v[96:99], a[168:171], v[52:55], v[96:99]
    s_add_u32 s52, s52, 22159360
    v_mfma_f32_16x16x32_bf16 v[100:103], a[160:163], v[48:51], v[100:103]
    buffer_store_dword v2, v3, s[32:35], s52 offen sc1
    v_mfma_f32_16x16x32_bf16 v[100:103], a[172:175], v[52:55], v[100:103]
    s_waitcnt lgkmcnt(2)
    s_mov_b32 s1, 22126592
    v_mfma_f32_16x16x32_bf16 v[80:83], a[176:179], v[24:27], v[80:83]
    buffer_load_dword v181, v18, s[32:35], s1 offen sc1
    v_mfma_f32_16x16x32_bf16 v[80:83], a[188:191], v[28:31], v[80:83]
    ds_read2st64_b64 v[40:43], v8 offset0:24 offset1:26
    v_mfma_f32_16x16x32_bf16 v[84:87], a[180:183], v[24:27], v[84:87]
Lh13:
    s_cbranch_execz Lh17
    ds_read2st64_b64 v[44:47], v22 offset0:28 offset1:30
    v_mfma_f32_16x16x32_bf16 v[84:87], a[192:195], v[28:31], v[84:87]
    buffer_load_dwordx4 a[144:147], v4, s[32:35], s66 offen offset:1024 sc1
    v_mfma_f32_16x16x32_bf16 v[88:91], a[184:187], v[24:27], v[88:91]
    ds_read2st64_b64 v[48:51], v9 offset0:24 offset1:26
    v_mfma_f32_16x16x32_bf16 v[88:91], a[196:199], v[28:31], v[88:91]
    s_waitcnt lgkmcnt(3)
    ds_read2st64_b64 v[52:55], v23 offset0:28 offset1:30
    v_mfma_f32_16x16x32_bf16 v[92:95], a[176:179], v[32:35], v[92:95]
    v_mfma_f32_16x16x32_bf16 v[92:95], a[188:191], v[36:39], v[92:95]
    buffer_load_dwordx4 a[148:151], v4, s[32:35], s66 offen offset:2048 sc1
    v_mfma_f32_16x16x32_bf16 v[96:99], a[180:183], v[32:35], v[96:99]
    v_mfma_f32_16x16x32_bf16 v[96:99], a[192:195], v[36:39], v[96:99]
    v_mfma_f32_16x16x32_bf16 v[100:103], a[184:187], v[32:35], v[100:103]
    v_mfma_f32_16x16x32_bf16 v[100:103], a[196:199], v[36:39], v[100:103]
    s_waitcnt lgkmcnt(2)
    v_mfma_f32_16x16x32_bf16 v[80:83], a[200:203], v[40:43], v[80:83]
    buffer_load_dwordx4 a[152:155], v4, s[32:35], s66 offen offset:3072 sc1
    v_mfma_f32_16x16x32_bf16 v[80:83], a[212:215], v[44:47], v[80:83]
    ds_read2st64_b64 v[24:27], v8 offset0:32 offset1:34
    v_mfma_f32_16x16x32_bf16 v[84:87], a[204:207], v[40:43], v[84:87]
    buffer_load_dwordx4 a[156:159], v6, s[32:35], s66 offen offset:0 sc1
    v_mfma_f32_16x16x32_bf16 v[84:87], a[216:219], v[44:47], v[84:87]
    s_add_u32 s66, s65, 30720
    ds_read2st64_b64 v[28:31], v22 offset0:36 offset1:38
    v_mfma_f32_16x16x32_bf16 v[88:91], a[208:211], v[40:43], v[88:91]
    ds_read2st64_b64 v[32:35], v9 offset0:32 offset1:34
    v_mfma_f32_16x16x32_bf16 v[88:91], a[220:223], v[44:47], v[88:91]
    s_waitcnt lgkmcnt(3)
    ds_read2st64_b64 v[36:39], v23 offset0:36 offset1:38
    v_mfma_f32_16x16x32_bf16 v[92:95], a[200:203], v[48:51], v[92:95]
    buffer_load_dwordx4 a[160:163], v4, s[32:35], s66 offen offset:0 sc1
    v_mfma_f32_16x16x32_bf16 v[92:95], a[212:215], v[52:55], v[92:95]
Lh14:
    s_cbranch_execz Lhopend
    s_waitcnt vmcnt(11)
    v_cmp_ne_u32 vcc, v2, v177
    v_cmp_ne_u32 s[16:17], v2, v179
    s_nop 1
    s_or_b64 vcc, vcc, s[16:17]
    s_cbranch_vccnz Lspin10
Lback10:
    v_mfma_f32_16x16x32_bf16 v[96:99], a[204:207], v[48:51], v[96:99]
    v_mov_b32 v144, v176
    v_mov_b32 v148, v176
    v_mfma_f32_16x16x32_bf16 v[96:99], a[216:219], v[52:55], v[96:99]
    buffer_load_dwordx4 a[164:167], v4, s[32:35], s66 offen offset:1024 sc1
    v_mfma_f32_16x16x32_bf16 v[100:103], a[208:211], v[48:51], v[100:103]
    v_mov_b32 v145, v178
    v_mov_b32 v149, v178
    v_mfma_f32_16x16x32_bf16 v[100:103], a[220:223], v[52:55], v[100:103]
    s_waitcnt lgkmcnt(2)
    v_permlane32_swap_b32 v144, v148
    v_mfma_f32_16x16x32_bf16 v[80:83], a[224:227], v[24:27], v[80:83]
    ds_read2st64_b64 v[40:43], v8 offset0:40 offset1:42
    v_permlane32_swap_b32 v145, v149
    v_mfma_f32_16x16x32_bf16 v[80:83], a[236:239], v[28:31], v[80:83]
    buffer_load_dwordx4 a[168:171], v4, s[32:35], s66 offen offset:2048 sc1
    v_mfma_f32_16x16x32_bf16 v[84:87], a[228:231], v[24:27], v[84:87]
    ds_read2st64_b64 v[44:47], v22 offset0:44 offset1:46
    v_mov_b32 v146, v144
    v_mfma_f32_16x16x32_bf16 v[84:87], a[0:3], v[28:31], v[84:87]
    ds_read2st64_b64 v[48:51], v9 offset0:40 offset1:42
    v_mov_b32 v150, v148
    v_mfma_f32_16x16x32_bf16 v[88:91], a[232:235], v[24:27], v[88:91]
    ds_read2st64_b64 v[52:55], v23 offset0:44 offset1:46
    v_mov_b32 v147, v145
    v_mfma_f32_16x16x32_bf16 v[88:91], a[4:7], v[28:31], v[88:91]
    s_waitcnt lgkmcnt(4)
    v_mov_b32 v151, v149
    v_permlane16_swap_b32 v144, v146
    v_mfma_f32_16x16x32_bf16 v[92:95], a[224:227], v[32:35], v[92:95]
    buffer_load_dwordx4 a[172:175], v4, s[32:35], s66 offen offset:3072 sc1
    v_mfma_f32_16x16x32_bf16 v[92:95], a[236:239], v[36:39], v[92:95]
    v_permlane16_swap_b32 v148, v150
    v_mfma_f32_16x16x32_bf16 v[96:99], a[228:231], v[32:35], v[96:99]
    buffer_load_dwordx4 a[176:179], v6, s[32:35], s66 offen offset:0 sc1
    v_mfma_f32_16x16x32_bf16 v[96:99], a[0:3], v[36:39], v[96:99]
    s_add_u32 s66, s65, 35840
    v_permlane16_swap_b32 v145, v147
    v_mfma_f32_16x16x32_bf16 v[100:103], a[232:235], v[32:35], v[100:103]
    ds_read_b128 a[200:203], v10 offset:0
    v_permlane16_swap_b32 v149, v151
    v_mfma_f32_16x16x32_bf16 v[100:103], a[4:7], v[36:39], v[100:103]
    s_waitcnt lgkmcnt(3)
    ds_read_b128 a[204:207], v10 offset:1024
    v_fma_f32 v136, v104, v145, v116
    v_mfma_f32_16x16x32_bf16 v[80:83], a[8:11], v[40:43], v[80:83]
    buffer_load_dwordx4 a[180:183], v4, s[32:35], s66 offen offset:0 sc1
    v_mfma_f32_16x16x32_bf16 v[80:83], a[20:23], v[44:47], v[80:83]
    ds_read2st64_b64 v[24:27], v8 offset0:48 offset1:50
    v_fma_f32 v137, v105, v145, v117
    v_mfma_f32_16x16x32_bf16 v[84:87], a[12:15], v[40:43], v[84:87]
    ds_read2st64_b64 v[28:31], v22 offset0:52 offset1:54
    v_fma_f32 v138, v106, v145, v118
    v_mfma_f32_16x16x32_bf16 v[84:87], a[24:27], v[44:47], v[84:87]
    buffer_load_dwordx4 a[184:187], v4, s[32:35], s66 offen offset:1024 sc1
    v_mfma_f32_16x16x32_bf16 v[88:91], a[16:19], v[40:43], v[88:91]
    ds_read2st64_b64 v[32:35], v9 offset0:48 offset1:50
    v_fma_f32 v139, v107, v145, v119
    v_mfma_f32_16x16x32_bf16 v[88:91], a[28:31], v[44:47], v[88:91]
    s_waitcnt lgkmcnt(5)
    ds_read2st64_b64 v[36:39], v23 offset0:52 offset1:54
    v_fma_f32 v136, v56, v144, v136
    v_mfma_f32_16x16x32_bf16 v[92:95], a[8:11], v[48:51], v[92:95]
    ds_read_b128 a[208:211], v10 offset:2048
    v_fma_f32 v137, v57, v144, v137
    v_mfma_f32_16x16x32_bf16 v[92:95], a[20:23], v[52:55], v[92:95]
    buffer_load_dwordx4 a[188:191], v4, s[32:35], s66 offen offset:2048 sc1
    v_mfma_f32_16x16x32_bf16 v[96:99], a[12:15], v[48:51], v[96:99]
    ds_read_b128 a[212:215], v10 offset:3072
    v_fma_f32 v138, v58, v144, v138
    v_mfma_f32_16x16x32_bf16 v[96:99], a[24:27], v[52:55], v[96:99]
    ds_read_b128 a[216:219], v10 offset:4096
    v_fma_f32 v139, v59, v144, v139
    v_mfma_f32_16x16x32_bf16 v[100:103], a[16:19], v[48:51], v[100:103]
    ds_read_b128 a[220:223], v10 offset:5120
    v_max_f32 v136, 0, v136
    v_mfma_f32_16x16x32_bf16 v[100:103], a[28:31], v[52:55], v[100:103]
    s_waitcnt lgkmcnt(6)
    ds_read_b128 a[224:227], v10 offset:6144
    v_max_f32 v137, 0, v137
    v_mfma_f32_16x16x32_bf16 v[80:83], a[32:35], v[24:27], v[80:83]
    buffer_load_dwordx4 a[192:195], v4, s[32:35], s66 offen offset:3072 sc1
    v_mfma_f32_16x16x32_bf16 v[80:83], a[44:47], v[28:31], v[80:83]
    ds_read2st64_b64 v[40:43], v8 offset0:56 offset1:58
    v_mul_f32 v136, v136, v138
    v_mfma_f32_16x16x32_bf16 v[84:87], a[36:39], v[24:27], v[84:87]
    buffer_load_dwordx4 a[196:199], v6, s[32:35], s66 offen offset:0 sc1
    v_mfma_f32_16x16x32_bf16 v[84:87], a[48:51], v[28:31], v[84:87]
    s_waitcnt vmcnt(14)
    s_mov_b32 s4, 22159360
    ds_read2st64_b64 v[44:47], v22 offset0:60 offset1:62
    v_cmp_ne_u32 vcc, v2, v181
    s_nop 1
    s_cbranch_vccnz Lspin11
Lback11:
    v_mfma_f32_16x16x32_bf16 v[88:91], a[40:43], v[24:27], v[88:91]
    buffer_load_dword v182, v18, s[32:35], s4 offen sc1
    v_mfma_f32_16x16x32_bf16 v[88:91], a[52:55], v[28:31], v[88:91]
    s_waitcnt lgkmcnt(7)
    ds_read2st64_b64 v[48:51], v9 offset0:56 offset1:58
    v_mul_f32 v137, v137, v139
    v_mfma_f32_16x16x32_bf16 v[92:95], a[32:35], v[32:35], v[92:95]
    s_add_u32 s68, s67, 0
    ds_read2st64_b64 v[52:55], v23 offset0:60 offset1:62
    v_cvt_pk_bf16_f32 v128, v136, v137
    v_mfma_f32_16x16x32_bf16 v[92:95], a[44:47], v[36:39], v[92:95]
    ds_read_b128 a[228:231], v10 offset:7168
    v_fma_f32 v140, v104, v147, v116
    v_mfma_f32_16x16x32_bf16 v[96:99], a[36:39], v[32:35], v[96:99]
    ds_read_b128 a[232:235], v10 offset:8192
    v_fma_f32 v141, v105, v147, v117
    v_mfma_f32_16x16x32_bf16 v[96:99], a[48:51], v[36:39], v[96:99]
    ds_read_b128 a[236:239], v10 offset:9216
    v_fma_f32 v142, v106, v147, v118
    v_mfma_f32_16x16x32_bf16 v[100:103], a[40:43], v[32:35], v[100:103]
    ds_read_b128 a[0:3], v11 offset:0
    v_fma_f32 v143, v107, v147, v119
    v_mfma_f32_16x16x32_bf16 v[100:103], a[52:55], v[36:39], v[100:103]
    s_waitcnt lgkmcnt(6)
    ds_read_b128 a[4:7], v11 offset:1024
    v_fma_f32 v140, v68, v146, v140
    v_mfma_f32_16x16x32_bf16 v[80:83], a[56:59], v[40:43], v[80:83]
    buffer_load_dwordx4 a[40:43], v4, s[32:35], s68 offen offset:0 sc1
    v_mfma_f32_16x16x32_bf16 v[80:83], a[68:71], v[44:47], v[80:83]
    buffer_load_dwordx4 a[44:47], v4, s[32:35], s68 offen offset:1024 sc1
    v_mfma_f32_16x16x32_bf16 v[84:87], a[60:63], v[40:43], v[84:87]
    ds_read2st64_b64 v[24:27], v8 offset0:64 offset1:66
    v_fma_f32 v141, v69, v146, v141
    v_mfma_f32_16x16x32_bf16 v[84:87], a[72:75], v[44:47], v[84:87]
    ds_read2st64_b64 v[28:31], v22 offset0:68 offset1:70
    v_fma_f32 v142, v70, v146, v142
    v_mfma_f32_16x16x32_bf16 v[88:91], a[64:67], v[40:43], v[88:91]
    ds_read2st64_b64 v[32:35], v9 offset0:64 offset1:66
    v_fma_f32 v143, v71, v146, v143
    v_mfma_f32_16x16x32_bf16 v[88:91], a[76:79], v[44:47], v[88:91]
    s_waitcnt lgkmcnt(8)
    ds_read2st64_b64 v[36:39], v23 offset0:68 offset1:70
    v_max_f32 v140, 0, v140
    v_mfma_f32_16x16x32_bf16 v[92:95], a[56:59], v[48:51], v[92:95]
    buffer_load_dwordx4 a[48:51], v4, s[32:35], s68 offen offset:2048 sc1
    v_mfma_f32_16x16x32_bf16 v[92:95], a[68:71], v[52:55], v[92:95]
    ds_read_b128 a[8:11], v11 offset:2048
    v_max_f32 v141, 0, v141
    v_mfma_f32_16x16x32_bf16 v[96:99], a[60:63], v[48:51], v[96:99]
    buffer_load_dwordx4 a[52:55], v4, s[32:35], s68 offen offset:3072 sc1
    v_mfma_f32_16x16x32_bf16 v[96:99], a[72:75], v[52:55], v[96:99]
    s_add_u32 s68, s67, 4096
    ds_read_b128 a[12:15], v11 offset:3072
    v_mul_f32 v140, v140, v142
    v_mfma_f32_16x16x32_bf16 v[100:103], a[64:67], v[48:51], v[100:103]
    ds_read_b128 a[16:19], v11 offset:4096
    v_mul_f32 v141, v141, v143
    v_mfma_f32_16x16x32_bf16 v[100:103], a[76:79], v[52:55], v[100:103]
    s_waitcnt lgkmcnt(5)
    ds_read_b128 a[20:23], v11 offset:5120
    v_cvt_pk_bf16_f32 v129, v140, v141
    v_mfma_f32_16x16x32_bf16 v[80:83], a[80:83], v[24:27], v[80:83]
    buffer_load_dwordx4 a[56:59], v4, s[32:35], s68 offen offset:0 sc1
    v_mfma_f32_16x16x32_bf16 v[80:83], a[92:95], v[28:31], v[80:83]
    ds_read2st64_b64 v[40:43], v8 offset0:72 offset1:74
    v_fma_f32 v136, v108, v145, v120
    v_mfma_f32_16x16x32_bf16 v[84:87], a[84:87], v[24:27], v[84:87]
    ds_read2st64_b64 v[44:47], v22 offset0:76 offset1:78
    v_fma_f32 v137, v109, v145, v121
    v_mfma_f32_16x16x32_bf16 v[84:87], a[96:99], v[28:31], v[84:87]
    buffer_load_dwordx4 a[60:63], v4, s[32:35], s68 offen offset:1024 sc1
    v_mfma_f32_16x16x32_bf16 v[88:91], a[88:91], v[24:27], v[88:91]
    ds_read2st64_b64 v[48:51], v9 offset0:72 offset1:74
    v_fma_f32 v138, v110, v145, v122
    v_mfma_f32_16x16x32_bf16 v[88:91], a[100:103], v[28:31], v[88:91]
    s_waitcnt lgkmcnt(7)
    ds_read2st64_b64 v[52:55], v23 offset0:76 offset1:78
    v_fma_f32 v139, v111, v145, v123
    v_mfma_f32_16x16x32_bf16 v[92:95], a[80:83], v[32:35], v[92:95]
    ds_read_b128 a[24:27], v11 offset:6144
    v_fma_f32 v136, v60, v144, v136
    v_mfma_f32_16x16x32_bf16 v[92:95], a[92:95], v[36:39], v[92:95]
    buffer_load_dwordx4 a[64:67], v4, s[32:35], s68 offen offset:2048 sc1
    v_mfma_f32_16x16x32_bf16 v[96:99], a[84:87], v[32:35], v[96:99]
    ds_read_b128 a[28:31], v11 offset:7168
    v_fma_f32 v137, v61, v144, v137
    v_mfma_f32_16x16x32_bf16 v[96:99], a[96:99], v[36:39], v[96:99]
    ds_read_b128 a[32:35], v11 offset:8192
    v_fma_f32 v138, v62, v144, v138
    v_mfma_f32_16x16x32_bf16 v[100:103], a[88:91], v[32:35], v[100:103]
    ds_read_b128 a[36:39], v11 offset:9216
    v_fma_f32 v139, v63, v144, v139
    v_mfma_f32_16x16x32_bf16 v[100:103], a[100:103], v[36:39], v[100:103]
    s_waitcnt lgkmcnt(6)
    v_max_f32 v136, 0, v136
    v_max_f32 v137, 0, v137
    v_mfma_f32_16x16x32_bf16 v[80:83], a[104:107], v[40:43], v[80:83]
    buffer_load_dwordx4 a[68:71], v4, s[32:35], s68 offen offset:3072 sc1
    v_mfma_f32_16x16x32_bf16 v[80:83], a[116:119], v[44:47], v[80:83]
    s_add_u32 s68, s67, 8192
    v_mul_f32 v136, v136, v138
    v_mul_f32 v137, v137, v139
    v_mfma_f32_16x16x32_bf16 v[84:87], a[108:111], v[40:43], v[84:87]
    buffer_load_dwordx4 a[72:75], v4, s[32:35], s68 offen offset:0 sc1
    v_mfma_f32_16x16x32_bf16 v[84:87], a[120:123], v[44:47], v[84:87]
    v_cvt_pk_bf16_f32 v130, v136, v137
    v_fma_f32 v140, v108, v147, v120
    v_mfma_f32_16x16x32_bf16 v[88:91], a[112:115], v[40:43], v[88:91]
    v_fma_f32 v141, v109, v147, v121
    v_fma_f32 v142, v110, v147, v122
    v_mfma_f32_16x16x32_bf16 v[88:91], a[124:127], v[44:47], v[88:91]
    s_waitcnt lgkmcnt(4)
    v_fma_f32 v143, v111, v147, v123
    v_fma_f32 v140, v72, v146, v140
    v_mfma_f32_16x16x32_bf16 v[92:95], a[104:107], v[48:51], v[92:95]
    buffer_load_dwordx4 a[76:79], v4, s[32:35], s68 offen offset:1024 sc1
    v_mfma_f32_16x16x32_bf16 v[92:95], a[116:119], v[52:55], v[92:95]
    v_fma_f32 v141, v73, v146, v141
    v_fma_f32 v142, v74, v146, v142
    v_mfma_f32_16x16x32_bf16 v[96:99], a[108:111], v[48:51], v[96:99]
    v_fma_f32 v143, v75, v146, v143
    v_max_f32 v140, 0, v140
    v_mfma_f32_16x16x32_bf16 v[96:99], a[120:123], v[52:55], v[96:99]
    buffer_load_dwordx4 a[80:83], v4, s[32:35], s68 offen offset:2048 sc1
    v_mfma_f32_16x16x32_bf16 v[100:103], a[112:115], v[48:51], v[100:103]
    v_max_f32 v141, 0, v141
    v_mul_f32 v140, v140, v142
    v_mfma_f32_16x16x32_bf16 v[100:103], a[124:127], v[52:55], v[100:103]
    v_mul_f32 v141, v141, v143
    v_cvt_pk_bf16_f32 v131, v140, v141
    v_permlane32_swap_b32 v128, v129
    v_fma_f32 v136, v112, v145, v124
    v_fma_f32 v137, v113, v145, v125
    v_fma_f32 v138, v114, v145, v126
    v_fma_f32 v139, v115, v145, v127
    v_fma_f32 v136, v64, v144, v136
    v_fma_f32 v137, v65, v144, v137
    v_fma_f32 v138, v66, v144, v138
    v_fma_f32 v139, v67, v144, v139
    v_max_f32 v136, 0, v136
    v_max_f32 v137, 0, v137
    v_mul_f32 v136, v136, v138
    v_mul_f32 v137, v137, v139
    v_cvt_pk_bf16_f32 v132, v136, v137
    v_fma_f32 v140, v112, v147, v124
    v_fma_f32 v141, v113, v147, v125
    v_fma_f32 v142, v114, v147, v126
    v_fma_f32 v143, v115, v147, v127
    v_fma_f32 v140, v76, v146, v140
    v_fma_f32 v141, v77, v146, v141
    v_fma_f32 v142, v78, v146, v142
    v_fma_f32 v143, v79, v146, v143
    v_max_f32 v140, 0, v140
    v_max_f32 v141, 0, v141
    v_mul_f32 v140, v140, v142
    v_mul_f32 v141, v141, v143
    v_cvt_pk_bf16_f32 v134, v140, v141
    v_permlane32_swap_b32 v130, v131
    s_add_u32 s51, s94, 3145728
    v_permlane32_swap_b32 v132, v134
    buffer_store_dwordx4 v[128:131], v12, s[32:35], s51 offen sc1
    s_nop 0
    v_permlane16_swap_b32 v132, v133
    v_permlane16_swap_b32 v134, v135
    buffer_store_dwordx4 v[132:135], v13, s[32:35], s51 offen offset:512 sc1
    buffer_load_dwordx4 a[84:87], v4, s[32:35], s68 offen offset:3072 sc1
    v_pk_fma_f32 v[136:137], v[104:105], v[148:149], v[116:117] op_sel:[0,1,0] op_sel_hi:[1,1,1]
    v_pk_fma_f32 v[138:139], v[106:107], v[148:149], v[118:119] op_sel:[0,1,0] op_sel_hi:[1,1,1]
    v_pk_fma_f32 v[136:137], v[80:81], v[148:149], v[136:137] op_sel_hi:[1,0,1]
    v_pk_fma_f32 v[138:139], v[82:83], v[148:149], v[138:139] op_sel_hi:[1,0,1]
    v_max_f32 v136, 0, v136
    v_max_f32 v137, 0, v137
    v_pk_mul_f32 v[136:137], v[136:137], v[138:139]
    v_cvt_pk_bf16_f32 v128, v136, v137
    v_pk_fma_f32 v[140:141], v[104:105], v[150:151], v[116:117] op_sel:[0,1,0] op_sel_hi:[1,1,1]
    v_pk_fma_f32 v[142:143], v[106:107], v[150:151], v[118:119] op_sel:[0,1,0] op_sel_hi:[1,1,1]
    v_pk_fma_f32 v[140:141], v[92:93], v[150:151], v[140:141] op_sel_hi:[1,0,1]
    v_pk_fma_f32 v[142:143], v[94:95], v[150:151], v[142:143] op_sel_hi:[1,0,1]
    v_max_f32 v140, 0, v140
    v_max_f32 v141, 0, v141
    v_pk_mul_f32 v[140:141], v[140:141], v[142:143]
    v_cvt_pk_bf16_f32 v129, v140, v141
    v_pk_fma_f32 v[136:137], v[108:109], v[148:149], v[120:121] op_sel:[0,1,0] op_sel_hi:[1,1,1]
    v_pk_fma_f32 v[138:139], v[110:111], v[148:149], v[122:123] op_sel:[0,1,0] op_sel_hi:[1,1,1]
    v_pk_fma_f32 v[136:137], v[84:85], v[148:149], v[136:137] op_sel_hi:[1,0,1]
    v_pk_fma_f32 v[138:139], v[86:87], v[148:149], v[138:139] op_sel_hi:[1,0,1]
    v_max_f32 v136, 0, v136
    v_max_f32 v137, 0, v137
    v_pk_mul_f32 v[136:137], v[136:137], v[138:139]
    v_cvt_pk_bf16_f32 v130, v136, v137
    v_pk_fma_f32 v[140:141], v[108:109], v[150:151], v[120:121] op_sel:[0,1,0] op_sel_hi:[1,1,1]
    v_pk_fma_f32 v[142:143], v[110:111], v[150:151], v[122:123] op_sel:[0,1,0] op_sel_hi:[1,1,1]
    v_pk_fma_f32 v[140:141], v[96:97], v[150:151], v[140:141] op_sel_hi:[1,0,1]
    v_pk_fma_f32 v[142:143], v[98:99], v[150:151], v[142:143] op_sel_hi:[1,0,1]
    v_max_f32 v140, 0, v140
    v_max_f32 v141, 0, v141
    v_pk_mul_f32 v[140:141], v[140:141], v[142:143]
    v_cvt_pk_bf16_f32 v131, v140, v141
    v_permlane32_swap_b32 v128, v129
    v_pk_fma_f32 v[136:137], v[112:113], v[148:149], v[124:125] op_sel:[0,1,0] op_sel_hi:[1,1,1]
    v_pk_fma_f32 v[138:139], v[114:115], v[148:149], v[126:127] op_sel:[0,1,0] op_sel_hi:[1,1,1]
    v_pk_fma_f32 v[136:137], v[88:89], v[148:149], v[136:137] op_sel_hi:[1,0,1]
    v_pk_fma_f32 v[138:139], v[90:91], v[148:149], v[138:139] op_sel_hi:[1,0,1]
    v_max_f32 v136, 0, v136
    v_max_f32 v137, 0, v137
    v_pk_mul_f32 v[136:137], v[136:137], v[138:139]
    v_cvt_pk_bf16_f32 v132, v136, v137
    v_pk_fma_f32 v[140:141], v[112:113], v[150:151], v[124:125] op_sel:[0,1,0] op_sel_hi:[1,1,1]
    v_pk_fma_f32 v[142:143], v[114:115], v[150:151], v[126:127] op_sel:[0,1,0] op_sel_hi:[1,1,1]
    v_pk_fma_f32 v[140:141], v[100:101], v[150:151], v[140:141] op_sel_hi:[1,0,1]
    v_pk_fma_f32 v[142:143], v[102:103], v[150:151], v[142:143] op_sel_hi:[1,0,1]
    v_max_f32 v140, 0, v140
    v_max_f32 v141, 0, v141
    v_pk_mul_f32 v[140:141], v[140:141], v[142:143]
    v_cvt_pk_bf16_f32 v134, v140, v141
    v_permlane32_swap_b32 v130, v131
    s_add_u32 s51, s95, 3145728
    v_permlane32_swap_b32 v132, v134
    buffer_store_dwordx4 v[128:131], v12, s[32:35], s51 offen sc1
    s_nop 0
    v_permlane16_swap_b32 v132, v133
    v_permlane16_swap_b32 v134, v135
    buffer_store_dwordx4 v[132:135], v13, s[32:35], s51 offen offset:512 sc1
    s_waitcnt vmcnt(15)
    v_mfma_f32_16x16x32_bf16 v[56:59], v[184:187], a[40:43], 0
    v_cmp_ne_u32 vcc, v2, v182
    s_nop 1
    s_cbranch_vccnz Lspin12
Lback12:
    s_waitcnt vmcnt(14)
    v_mfma_f32_16x16x32_bf16 v[56:59], v[204:207], a[44:47], v[56:59]
    s_add_u32 s68, s71, 0
    v_and_b32 v48, 15, v1
    v_lshrrev_b32 v49, 4, v1
    v_mfma_f32_16x16x32_bf16 v[60:63], v[188:191], a[40:43], 0
    buffer_load_dwordx4 a[88:91], v4, s[32:35], s68 offen offset:0 sc1
    v_mfma_f32_16x16x32_bf16 v[60:63], v[208:211], a[44:47], v[60:63]
    buffer_load_dwordx4 a[92:95], v4, s[32:35], s68 offen offset:1024 sc1
    v_mfma_f32_16x16x32_bf16 v[64:67], v[192:195], a[40:43], 0
    buffer_load_dwordx4 a[96:99], v4, s[32:35], s68 offen offset:2048 sc1
    v_mfma_f32_16x16x32_bf16 v[64:67], v[212:215], a[44:47], v[64:67]
    buffer_load_dwordx4 a[100:103], v4, s[32:35], s68 offen offset:3072 sc1
    v_mfma_f32_16x16x32_bf16 v[68:71], v[196:199], a[40:43], 0
    s_add_u32 s68, s71, 4096
    v_lshrrev_b32 v52, 2, v1
    v_and_b32 v53, 3, v1
    v_mfma_f32_16x16x32_bf16 v[68:71], v[216:219], a[44:47], v[68:71]
    buffer_load_dwordx4 a[104:107], v4, s[32:35], s68 offen offset:0 sc1
    v_mfma_f32_16x16x32_bf16 v[72:75], v[200:203], a[40:43], 0
    v_lshlrev_b32 v19, 4, v53
    s_mul_i32 s55, s69, 320
    v_mfma_f32_16x16x32_bf16 v[72:75], v[220:223], a[44:47], v[72:75]
    s_waitcnt vmcnt(18)
    s_add_u32 s55, s55, 425984
    s_lshl_b32 s56, s44, 6
    s_add_u32 s56, s56, s55
    v_mfma_f32_16x16x32_bf16 v[56:59], v[224:227], a[48:51], v[56:59]
    s_waitcnt vmcnt(8)
    s_barrier
    s_lshl_b32 s52, s3, 7
    v_mfma_f32_16x16x32_bf16 v[56:59], v[244:247], a[52:55], v[56:59]
    s_add_u32 s52, s52, 22192128
    s_add_u32 s57, s55, 4096
    s_add_u32 s58, s56, 4096
    v_mfma_f32_16x16x32_bf16 v[60:63], v[228:231], a[48:51], v[60:63]
    buffer_store_dword v2, v3, s[32:35], s52 offen sc1
    v_mfma_f32_16x16x32_bf16 v[60:63], v[248:251], a[52:55], v[60:63]
    buffer_load_dwordx4 a[108:111], v4, s[32:35], s68 offen offset:1024 sc1
    v_mfma_f32_16x16x32_bf16 v[64:67], v[232:235], a[48:51], v[64:67]
    v_lshlrev_b32 v50, 14, v49
    v_lshl_add_u32 v50, v48, 3, v50
    v_mfma_f32_16x16x32_bf16 v[64:67], v[252:255], a[52:55], v[64:67]
    buffer_load_dwordx4 a[112:115], v4, s[32:35], s68 offen offset:2048 sc1
    v_mfma_f32_16x16x32_bf16 v[68:71], v[236:239], a[48:51], v[68:71]
    s_lshl_b32 s53, s44, 16
    v_add_u32 v8, s53, v50
    v_mov_b32 v51, 0x80000000
    v_mfma_f32_16x16x32_bf16 v[68:71], a[240:243], a[52:55], v[68:71]
    s_and_b32 s53, s44, 1
    v_lshrrev_b32 v50, 5, v1
    v_cmp_eq_u32 s[10:11], s53, v50
    v_mfma_f32_16x16x32_bf16 v[72:75], v[240:243], a[48:51], v[72:75]
    buffer_load_dwordx4 a[116:119], v4, s[32:35], s68 offen offset:3072 sc1
    v_mfma_f32_16x16x32_bf16 v[72:75], a[244:247], a[52:55], v[72:75]
    s_add_u32 s68, s71, 8192
    s_lshr_b32 s12, s44, 1
    v_lshlrev_b32 v50, 14, v53
    v_mfma_f32_16x16x32_bf16 v[56:59], a[248:251], a[56:59], v[56:59]
    v_lshl_add_u32 v50, v52, 3, v50
    s_lshl_b32 s53, s12, 8
    v_mfma_f32_16x16x32_bf16 v[56:59], a[140:143], a[60:63], v[56:59]
    s_add_u32 s53, s53, 262144
    v_add_u32 v50, s53, v50
    v_cndmask_b32 v9, v51, v50, s[10:11]
    v_mfma_f32_16x16x32_bf16 v[60:63], a[252:255], a[56:59], v[60:63]
    buffer_load_dwordx4 a[120:123], v4, s[32:35], s68 offen offset:0 sc1
    v_mfma_f32_16x16x32_bf16 v[60:63], a[144:147], a[60:63], v[60:63]
    s_mul_i32 s5, s69, 327680
    s_lshl_b32 s53, s47, 6
    s_and_b32 s54, s48, 4
    v_mfma_f32_16x16x32_bf16 v[64:67], a[128:131], a[56:59], v[64:67]
    s_lshl_b32 s54, s54, 2
    s_add_u32 s53, s53, s54
    s_lshl_b32 s54, s53, 3
    v_mfma_f32_16x16x32_bf16 v[64:67], a[148:151], a[60:63], v[64:67]
    buffer_load_dwordx4 a[124:127], v4, s[32:35], s68 offen offset:1024 sc1
    v_mfma_f32_16x16x32_bf16 v[68:71], a[132:135], a[56:59], v[68:71]
    s_add_u32 s5, s5, s54
    s_add_u32 s5, s5, 6291456
    s_mul_i32 s6, s53, 1280
    v_mfma_f32_16x16x32_bf16 v[68:71], a[152:155], a[60:63], v[68:71]
    s_mul_i32 s54, s69, 160
    s_add_u32 s6, s6, s54
    v_mul_u32_u24 v50, 1280, v52
    v_mfma_f32_16x16x32_bf16 v[72:75], a[136:139], a[56:59], v[72:75]
    buffer_load_dwordx4 v[136:139], v4, s[32:35], s68 offen offset:2048 sc1
    v_mfma_f32_16x16x32_bf16 v[72:75], a[156:159], a[60:63], v[72:75]
    v_lshl_add_u32 v50, v53, 3, v50
    s_lshl_b32 s53, s44, 5
    v_mfma_f32_16x16x32_bf16 v[56:59], a[160:163], a[64:67], v[56:59]
    v_add_u32 v15, s53, v50
    s_mul_i32 s53, s12, 40960
    v_mfma_f32_16x16x32_bf16 v[56:59], a[180:183], a[68:71], v[56:59]
    buffer_load_dwordx4 v[140:143], v4, s[32:35], s68 offen offset:3072 sc1
    v_mfma_f32_16x16x32_bf16 v[60:63], a[164:167], a[64:67], v[60:63]
    s_add_u32 s53, s53, 128
    v_add_u32 v50, s53, v50
    v_cndmask_b32 v16, v51, v50, s[10:11]
    v_mfma_f32_16x16x32_bf16 v[60:63], a[184:187], a[68:71], v[60:63]
    v_lshl_add_u32 v17, v53, 4, v52
    v_lshlrev_b32 v17, 2, v17
    v_mfma_f32_16x16x32_bf16 v[64:67], a[168:171], a[64:67], v[64:67]
    v_lshl_add_u32 v50, v49, 2, v48
    v_and_b32 v50, 15, v50
    v_mfma_f32_16x16x32_bf16 v[64:67], a[188:191], a[68:71], v[64:67]
    v_lshl_add_u32 v50, v49, 4, v50
    s_mul_i32 s53, s44, 5120
    v_mfma_f32_16x16x32_bf16 v[68:71], a[172:175], a[64:67], v[68:71]
    s_add_u32 s53, s53, 40960
    v_lshl_add_u32 v50, v50, 4, s53
    s_mul_i32 s54, s12, 20480
    v_mfma_f32_16x16x32_bf16 v[68:71], a[192:195], a[68:71], v[68:71]
    v_add_u32 v20, s54, v50
    s_sub_u32 s53, 20480, s54
    v_mfma_f32_16x16x32_bf16 v[72:75], a[176:179], a[64:67], v[72:75]
    v_add_u32 v22, s53, v50
    v_lshl_add_u32 v50, v53, 2, v52
    v_mfma_f32_16x16x32_bf16 v[72:75], a[196:199], a[68:71], v[72:75]
    v_and_b32 v50, 15, v50
    v_lshl_add_u32 v50, v53, 4, v50
    v_mfma_f32_16x16x32_bf16 v[56:59], a[200:203], a[72:75], v[56:59]
    v_lshlrev_b32 v50, 4, v50
    s_lshl_b32 s53, s44, 10
    v_mfma_f32_16x16x32_bf16 v[56:59], a[220:223], a[76:79], v[56:59]
    s_add_u32 s53, s53, 40960
    v_add_u32 v21, s53, v50
    s_add_u32 s54, s54, 45056
    v_mfma_f32_16x16x32_bf16 v[60:63], a[204:207], a[72:75], v[60:63]
    v_add_u32 v14, s54, v50
    s_mov_b32 s36, s28
    v_mfma_f32_16x16x32_bf16 v[60:63], a[224:227], a[76:79], v[60:63]
    s_mov_b32 s37, s29
    s_mov_b32 s38, 2621440
    s_mov_b32 s39, 0x20000
    v_mfma_f32_16x16x32_bf16 v[64:67], a[208:211], a[72:75], v[64:67]
    v_mfma_f32_16x16x32_bf16 v[64:67], a[228:231], a[76:79], v[64:67]
    v_mfma_f32_16x16x32_bf16 v[68:71], a[212:215], a[72:75], v[68:71]
    v_mfma_f32_16x16x32_bf16 v[68:71], a[232:235], a[76:79], v[68:71]
    v_mfma_f32_16x16x32_bf16 v[72:75], a[216:219], a[72:75], v[72:75]
    s_waitcnt vmcnt(13)
    s_barrier
    s_lshl_b32 s52, s3, 7
    v_mfma_f32_16x16x32_bf16 v[72:75], a[236:239], a[76:79], v[72:75]
    s_add_u32 s52, s52, 22261760
    v_mfma_f32_16x16x32_bf16 v[56:59], a[0:3], a[80:83], v[56:59]
    buffer_store_dword v2, v3, s[32:35], s52 offen sc1
    v_mfma_f32_16x16x32_bf16 v[56:59], a[20:23], a[84:87], v[56:59]
    buffer_load_dwordx4 v[144:147], v19, s[32:35], s56 offen sc1
    v_mfma_f32_16x16x32_bf16 v[60:63], a[4:7], a[80:83], v[60:63]
    s_waitcnt lgkmcnt(3)
    s_mov_b32 s1, 22192128
    v_mfma_f32_16x16x32_bf16 v[60:63], a[24:27], a[84:87], v[60:63]
    buffer_load_dword v181, v18, s[32:35], s1 offen sc1
    v_mfma_f32_16x16x32_bf16 v[64:67], a[8:11], a[80:83], v[64:67]
    s_waitcnt lgkmcnt(2)
    buffer_load_dwordx4 v[148:151], v19, s[32:35], s55 offen offset:256 sc1
    v_mfma_f32_16x16x32_bf16 v[64:67], a[28:31], a[84:87], v[64:67]
    buffer_load_dwordx4 v[40:43], v19, s[32:35], s58 offen sc1
    v_mfma_f32_16x16x32_bf16 v[68:71], a[12:15], a[80:83], v[68:71]
    s_waitcnt lgkmcnt(1)
    v_mfma_f32_16x16x32_bf16 v[68:71], a[32:35], a[84:87], v[68:71]
    buffer_load_dwordx4 v[44:47], v19, s[32:35], s57 offen offset:256 sc1
    v_mfma_f32_16x16x32_bf16 v[72:75], a[16:19], a[80:83], v[72:75]
    s_waitcnt lgkmcnt(0)
    s_add_u32 s54, s5, 0
    v_mfma_f32_16x16x32_bf16 v[72:75], a[36:39], a[84:87], v[72:75]
    s_waitcnt vmcnt(18)
    v_mfma_f32_16x16x32_bf16 v[76:79], v[184:187], a[88:91], 0
    s_waitcnt vmcnt(17)
    buffer_load_dwordx2 v[24:25], v8, s[32:35], s54 offen sc1
    v_mfma_f32_16x16x32_bf16 v[76:79], v[204:207], a[92:95], v[76:79]
    v_mfma_f32_16x16x32_bf16 v[80:83], v[188:191], a[88:91], 0
    v_mfma_f32_16x16x32_bf16 v[80:83], v[208:211], a[92:95], v[80:83]
    buffer_load_dwordx2 v[26:27], v8, s[32:35], s54 offen offset:256 sc1
    v_mfma_f32_16x16x32_bf16 v[84:87], v[192:195], a[88:91], 0
    ds_write_b128 v20, v[56:59] offset:0
    v_mfma_f32_16x16x32_bf16 v[84:87], v[212:215], a[92:95], v[84:87]
    v_mfma_f32_16x16x32_bf16 v[88:91], v[196:199], a[88:91], 0
    ds_write_b128 v20, v[60:63] offset:1024
    v_mfma_f32_16x16x32_bf16 v[88:91], v[216:219], a[92:95], v[88:91]
    buffer_load_dwordx2 v[28:29], v9, s[32:35], s54 offen sc1
    v_mfma_f32_16x16x32_bf16 v[92:95], v[200:203], a[88:91], 0
    s_min_u32 s54, s2, 1
    ds_write_b128 v20, v[64:67] offset:2048
    s_lshl_b32 s54, s54, 31
    v_mfma_f32_16x16x32_bf16 v[92:95], v[220:223], a[92:95], v[92:95]
    s_waitcnt vmcnt(19)
    v_or_b32 v183, s54, v3
    v_mfma_f32_16x16x32_bf16 v[76:79], v[224:227], a[96:99], v[76:79]
    s_waitcnt vmcnt(18)
    ds_write_b128 v20, v[68:71] offset:3072
    v_mfma_f32_16x16x32_bf16 v[76:79], v[244:247], a[100:103], v[76:79]
Lh15:
    s_cbranch_execz Lhopend
    v_mfma_f32_16x16x32_bf16 v[80:83], v[228:231], a[96:99], v[80:83]
    ds_write_b128 v20, v[72:75] offset:4096
    v_mfma_f32_16x16x32_bf16 v[80:83], v[248:251], a[100:103], v[80:83]
    buffer_store_dword v2, v183, s[32:35], 0 offen offset:0 sc1
    v_mfma_f32_16x16x32_bf16 v[84:87], v[232:235], a[96:99], v[84:87]
    v_mfma_f32_16x16x32_bf16 v[84:87], v[252:255], a[100:103], v[84:87]
    v_mfma_f32_16x16x32_bf16 v[88:91], v[236:239], a[96:99], v[88:91]
    v_mfma_f32_16x16x32_bf16 v[88:91], a[240:243], a[100:103], v[88:91]
    v_mfma_f32_16x16x32_bf16 v[92:95], v[240:243], a[96:99], v[92:95]
    v_mfma_f32_16x16x32_bf16 v[92:95], a[244:247], a[100:103], v[92:95]
    s_waitcnt vmcnt(18)
    v_mfma_f32_16x16x32_bf16 v[76:79], a[248:251], a[104:107], v[76:79]
    s_waitcnt vmcnt(16)
    v_mfma_f32_16x16x32_bf16 v[76:79], a[140:143], a[108:111], v[76:79]
    v_mfma_f32_16x16x32_bf16 v[80:83], a[252:255], a[104:107], v[80:83]
    v_mfma_f32_16x16x32_bf16 v[80:83], a[144:147], a[108:111], v[80:83]
    v_mfma_f32_16x16x32_bf16 v[84:87], a[128:131], a[104:107], v[84:87]
    v_mfma_f32_16x16x32_bf16 v[84:87], a[148:151], a[108:111], v[84:87]
    v_mfma_f32_16x16x32_bf16 v[88:91], a[132:135], a[104:107], v[88:91]
    v_mfma_f32_16x16x32_bf16 v[88:91], a[152:155], a[108:111], v[88:91]
    v_mfma_f32_16x16x32_bf16 v[92:95], a[136:139], a[104:107], v[92:95]
    v_mfma_f32_16x16x32_bf16 v[92:95], a[156:159], a[108:111], v[92:95]
    s_waitcnt vmcnt(15)
    v_mfma_f32_16x16x32_bf16 v[76:79], a[160:163], a[112:115], v[76:79]
    s_waitcnt vmcnt(7)
    v_cmp_ne_u32 vcc, v2, v181
    s_nop 1
    s_cbranch_vccnz Lspin14
Lback14:
    v_mfma_f32_16x16x32_bf16 v[76:79], a[180:183], a[116:119], v[76:79]
    s_add_u32 s68, s67, 3145728
    v_mfma_f32_16x16x32_bf16 v[80:83], a[164:167], a[112:115], v[80:83]
    s_mov_b32 s8, 22261760
    v_mfma_f32_16x16x32_bf16 v[80:83], a[184:187], a[116:119], v[80:83]
    buffer_load_dword v180, v18, s[32:35], s8 offen sc1
    v_mfma_f32_16x16x32_bf16 v[84:87], a[168:171], a[112:115], v[84:87]
Lh16:
    s_cbranch_execz Lhopend
    buffer_load_dwordx4 a[40:43], v4, s[32:35], s68 offen offset:0 sc1
    v_mfma_f32_16x16x32_bf16 v[84:87], a[188:191], a[116:119], v[84:87]
    buffer_load_dwordx4 a[44:47], v4, s[32:35], s68 offen offset:1024 sc1
    v_mfma_f32_16x16x32_bf16 v[88:91], a[172:175], a[112:115], v[88:91]
    buffer_load_dwordx4 a[48:51], v4, s[32:35], s68 offen offset:2048 sc1
    v_mfma_f32_16x16x32_bf16 v[88:91], a[192:195], a[116:119], v[88:91]
    v_mfma_f32_16x16x32_bf16 v[92:95], a[176:179], a[112:115], v[92:95]
    buffer_load_dwordx4 a[52:55], v4, s[32:35], s68 offen offset:3072 sc1
    v_mfma_f32_16x16x32_bf16 v[92:95], a[196:199], a[116:119], v[92:95]
    s_add_u32 s68, s67, 3149824
    v_mfma_f32_16x16x32_bf16 v[76:79], a[200:203], a[120:123], v[76:79]
    v_mfma_f32_16x16x32_bf16 v[76:79], a[220:223], a[124:127], v[76:79]
    v_mfma_f32_16x16x32_bf16 v[80:83], a[204:207], a[120:123], v[80:83]
    buffer_load_dwordx4 a[56:59], v4, s[32:35], s68 offen offset:0 sc1
    v_mfma_f32_16x16x32_bf16 v[80:83], a[224:227], a[124:127], v[80:83]
    v_mfma_f32_16x16x32_bf16 v[84:87], a[208:211], a[120:123], v[84:87]
    v_mfma_f32_16x16x32_bf16 v[84:87], a[228:231], a[124:127], v[84:87]
    buffer_load_dwordx4 a[60:63], v4, s[32:35], s68 offen offset:1024 sc1
    v_mfma_f32_16x16x32_bf16 v[88:91], a[212:215], a[120:123], v[88:91]
    s_waitcnt vmcnt(10)
    ds_bpermute_b32 v24, v17, v24
    v_mfma_f32_16x16x32_bf16 v[88:91], a[232:235], a[124:127], v[88:91]
    ds_bpermute_b32 v25, v17, v25
    v_mfma_f32_16x16x32_bf16 v[92:95], a[216:219], a[120:123], v[92:95]
    buffer_load_dwordx4 a[64:67], v4, s[32:35], s68 offen offset:2048 sc1
    v_mfma_f32_16x16x32_bf16 v[92:95], a[236:239], a[124:127], v[92:95]
    s_waitcnt vmcnt(10)
    ds_bpermute_b32 v26, v17, v26
    v_mfma_f32_16x16x32_bf16 v[76:79], a[0:3], v[136:139], v[76:79]
    s_waitcnt vmcnt(9)
    ds_bpermute_b32 v27, v17, v27
    v_lshlrev_b32 v160, 16, v28
    v_mfma_f32_16x16x32_bf16 v[76:79], a[20:23], v[140:143], v[76:79]
Lh17:
    s_cbranch_execz Lhopend
    buffer_load_dwordx4 a[68:71], v4, s[32:35], s68 offen offset:3072 sc1
    v_mfma_f32_16x16x32_bf16 v[80:83], a[4:7], v[136:139], v[80:83]
    s_add_u32 s68, s67, 3153920
    v_and_b32 v161, 0xffff0000, v28
    v_lshlrev_b32 v162, 16, v29
    v_mfma_f32_16x16x32_bf16 v[80:83], a[24:27], v[140:143], v[80:83]
    v_and_b32 v163, 0xffff0000, v29
    v_mul_f32 v160, v160, v148
    v_mfma_f32_16x16x32_bf16 v[84:87], a[8:11], v[136:139], v[84:87]
    buffer_load_dwordx4 a[72:75], v4, s[32:35], s68 offen offset:0 sc1
    v_mfma_f32_16x16x32_bf16 v[84:87], a[28:31], v[140:143], v[84:87]
    v_mul_f32 v161, v161, v149
    v_mul_f32 v162, v162, v150
    v_mfma_f32_16x16x32_bf16 v[88:91], a[12:15], v[136:139], v[88:91]
    s_waitcnt lgkmcnt(3)
    v_mul_f32 v163, v163, v151
    v_lshlrev_b32 v152, 16, v24
    v_mfma_f32_16x16x32_bf16 v[88:91], a[32:35], v[140:143], v[88:91]
    s_waitcnt lgkmcnt(2)
    v_and_b32 v153, 0xffff0000, v24
    v_lshlrev_b32 v154, 16, v25
    v_mfma_f32_16x16x32_bf16 v[92:95], a[16:19], v[136:139], v[92:95]
    buffer_load_dwordx4 a[76:79], v4, s[32:35], s68 offen offset:1024 sc1
    v_mfma_f32_16x16x32_bf16 v[92:95], a[36:39], v[140:143], v[92:95]
    s_waitcnt vmcnt(9)
    v_and_b32 v155, 0xffff0000, v25
    v_mul_f32 v152, v152, v144
    v_mfma_f32_16x16x32_bf16 v[56:59], v[184:187], a[40:43], 0
    s_waitcnt vmcnt(8)
    v_mul_f32 v153, v153, v145
    v_mul_f32 v154, v154, v146
    v_mfma_f32_16x16x32_bf16 v[56:59], v[204:207], a[44:47], v[56:59]
    buffer_load_dwordx4 a[80:83], v4, s[32:35], s68 offen offset:2048 sc1
    v_mfma_f32_16x16x32_bf16 v[60:63], v[188:191], a[40:43], 0
    s_waitcnt lgkmcnt(1)
    v_mul_f32 v155, v155, v147
    v_lshlrev_b32 v156, 16, v26
    v_mfma_f32_16x16x32_bf16 v[60:63], v[208:211], a[44:47], v[60:63]
    s_waitcnt lgkmcnt(0)
    v_and_b32 v157, 0xffff0000, v26
    v_lshlrev_b32 v158, 16, v27
    v_mfma_f32_16x16x32_bf16 v[64:67], v[192:195], a[40:43], 0
    buffer_load_dwordx4 a[84:87], v4, s[32:35], s68 offen offset:3072 sc1
    v_mfma_f32_16x16x32_bf16 v[64:67], v[212:215], a[44:47], v[64:67]
    v_cmp_ne_u32 vcc, v2, v180
    s_nop 1
    s_cbranch_vccnz Lspin15
Lback15:
    v_mfma_f32_16x16x32_bf16 v[68:71], v[196:199], a[40:43], 0
    s_add_u32 s68, s71, 3145728
    v_and_b32 v159, 0xffff0000, v27
    v_mul_f32 v156, v156, v144
    v_mfma_f32_16x16x32_bf16 v[68:71], v[216:219], a[44:47], v[68:71]
    buffer_load_dwordx4 a[88:91], v4, s[32:35], s68 offen offset:0 sc1
    v_mfma_f32_16x16x32_bf16 v[72:75], v[200:203], a[40:43], 0
    v_mul_f32 v157, v157, v145
    v_mul_f32 v158, v158, v146
    v_mfma_f32_16x16x32_bf16 v[72:75], v[220:223], a[44:47], v[72:75]
    s_waitcnt vmcnt(10)
    v_mul_f32 v159, v159, v147
    v_mfma_f32_16x16x32_bf16 v[56:59], v[224:227], a[48:51], v[56:59]
    s_waitcnt vmcnt(9)
    buffer_load_dwordx4 a[92:95], v4, s[32:35], s68 offen offset:1024 sc1
    v_mfma_f32_16x16x32_bf16 v[56:59], v[244:247], a[52:55], v[56:59]
    ds_write_b128 v22, v[76:79] offset:0
    v_mfma_f32_16x16x32_bf16 v[60:63], v[228:231], a[48:51], v[60:63]
    v_mfma_f32_16x16x32_bf16 v[60:63], v[248:251], a[52:55], v[60:63]
    buffer_load_dwordx4 a[96:99], v4, s[32:35], s68 offen offset:2048 sc1
    v_mfma_f32_16x16x32_bf16 v[64:67], v[232:235], a[48:51], v[64:67]
    ds_write_b128 v22, v[80:83] offset:1024
    v_mfma_f32_16x16x32_bf16 v[64:67], v[252:255], a[52:55], v[64:67]
    v_mfma_f32_16x16x32_bf16 v[68:71], v[236:239], a[48:51], v[68:71]
    ds_write_b128 v22, v[84:87] offset:2048
    v_mfma_f32_16x16x32_bf16 v[68:71], a[240:243], a[52:55], v[68:71]
    buffer_load_dwordx4 a[100:103], v4, s[32:35], s68 offen offset:3072 sc1
    v_mfma_f32_16x16x32_bf16 v[72:75], v[240:243], a[48:51], v[72:75]
    s_add_u32 s68, s71, 3149824
    ds_write_b128 v22, v[88:91] offset:3072
    v_mfma_f32_16x16x32_bf16 v[72:75], a[244:247], a[52:55], v[72:75]
    s_waitcnt vmcnt(11)
    v_mfma_f32_16x16x32_bf16 v[56:59], a[248:251], a[56:59], v[56:59]
    s_waitcnt vmcnt(10)
    buffer_load_dwordx4 a[104:107], v4, s[32:35], s68 offen offset:0 sc1
    v_mfma_f32_16x16x32_bf16 v[56:59], a[140:143], a[60:63], v[56:59]
    ds_write_b128 v22, v[92:95] offset:4096
    v_mfma_f32_16x16x32_bf16 v[60:63], a[252:255], a[56:59], v[60:63]
    v_mfma_f32_16x16x32_bf16 v[60:63], a[144:147], a[60:63], v[60:63]
    buffer_load_dwordx4 a[108:111], v4, s[32:35], s68 offen offset:1024 sc1
    v_mfma_f32_16x16x32_bf16 v[64:67], a[128:131], a[56:59], v[64:67]
    v_mfma_f32_16x16x32_bf16 v[64:67], a[148:151], a[60:63], v[64:67]
    v_mfma_f32_16x16x32_bf16 v[68:71], a[132:135], a[56:59], v[68:71]
    buffer_load_dwordx4 a[112:115], v4, s[32:35], s68 offen offset:2048 sc1
    v_mfma_f32_16x16x32_bf16 v[68:71], a[152:155], a[60:63], v[68:71]
    s_waitcnt lgkmcnt(0)
    s_barrier
    ds_read_b128 v[96:99], v21 offset:0
    v_mfma_f32_16x16x32_bf16 v[72:75], a[136:139], a[56:59], v[72:75]
    ds_read_b128 v[100:103], v21 offset:5120
    v_mfma_f32_16x16x32_bf16 v[72:75], a[156:159], a[60:63], v[72:75]
    s_waitcnt vmcnt(12)
    buffer_load_dwordx4 a[116:119], v4, s[32:35], s68 offen offset:3072 sc1
    v_mfma_f32_16x16x32_bf16 v[56:59], a[160:163], a[64:67], v[56:59]
    s_waitcnt vmcnt(12)
    s_add_u32 s68, s71, 3153920
    ds_read_b128 v[104:107], v21 offset:10240
    v_mfma_f32_16x16x32_bf16 v[56:59], a[180:183], a[68:71], v[56:59]
    ds_read_b128 v[108:111], v21 offset:15360
    v_mfma_f32_16x16x32_bf16 v[60:63], a[164:167], a[64:67], v[60:63]
    ds_read_b128 v[112:115], v21 offset:20480
    v_mfma_f32_16x16x32_bf16 v[60:63], a[184:187], a[68:71], v[60:63]
    buffer_load_dwordx4 a[120:123], v4, s[32:35], s68 offen offset:0 sc1
    v_mfma_f32_16x16x32_bf16 v[64:67], a[168:171], a[64:67], v[64:67]
    ds_read_b128 v[116:119], v21 offset:25600
    v_mfma_f32_16x16x32_bf16 v[64:67], a[188:191], a[68:71], v[64:67]
    ds_read_b128 v[120:123], v21 offset:30720
    v_mfma_f32_16x16x32_bf16 v[68:71], a[172:175], a[64:67], v[68:71]
    buffer_load_dwordx4 a[124:127], v4, s[32:35], s68 offen offset:1024 sc1
    v_mfma_f32_16x16x32_bf16 v[68:71], a[192:195], a[68:71], v[68:71]
    ds_read_b128 v[124:127], v21 offset:35840
    v_mfma_f32_16x16x32_bf16 v[72:75], a[176:179], a[64:67], v[72:75]
    ds_read_b128 v[164:167], v14 offset:0
    v_mfma_f32_16x16x32_bf16 v[72:75], a[196:199], a[68:71], v[72:75]
    s_waitcnt vmcnt(13)
    buffer_load_dwordx4 v[136:139], v4, s[32:35], s68 offen offset:2048 sc1
    v_mfma_f32_16x16x32_bf16 v[56:59], a[200:203], a[72:75], v[56:59]
    s_waitcnt vmcnt(13)
    ds_read_b128 v[168:171], v14 offset:5120
    v_mfma_f32_16x16x32_bf16 v[56:59], a[220:223], a[76:79], v[56:59]
    ds_read_b128 v[172:175], v14 offset:10240
    v_mfma_f32_16x16x32_bf16 v[60:63], a[204:207], a[72:75], v[60:63]
    buffer_load_dwordx4 v[140:143], v4, s[32:35], s68 offen offset:3072 sc1
    v_mfma_f32_16x16x32_bf16 v[60:63], a[224:227], a[76:79], v[60:63]
    s_waitcnt lgkmcnt(9)
    ds_read_b128 v[176:179], v14 offset:15360
    v_add_f32 v96, v96, v100
    v_mfma_f32_16x16x32_bf16 v[64:67], a[208:211], a[72:75], v[64:67]
    v_add_f32 v97, v97, v101
    v_add_f32 v98, v98, v102
    v_mfma_f32_16x16x32_bf16 v[64:67], a[228:231], a[76:79], v[64:67]
    s_waitcnt lgkmcnt(8)
    v_add_f32 v99, v99, v103
    v_add_f32 v104, v104, v108
    v_mfma_f32_16x16x32_bf16 v[68:71], a[212:215], a[72:75], v[68:71]
    v_add_f32 v105, v105, v109
    v_add_f32 v106, v106, v110
    v_mfma_f32_16x16x32_bf16 v[68:71], a[232:235], a[76:79], v[68:71]
    v_add_f32 v107, v107, v111
    v_add_f32 v96, v96, v104
    v_mfma_f32_16x16x32_bf16 v[72:75], a[216:219], a[72:75], v[72:75]
    v_add_f32 v97, v97, v105
    v_add_f32 v98, v98, v106
    v_mfma_f32_16x16x32_bf16 v[72:75], a[236:239], a[76:79], v[72:75]
    s_waitcnt vmcnt(13)
    v_add_f32 v99, v99, v107
    v_fma_f32 v96, v96, v40, v152
    v_mfma_f32_16x16x32_bf16 v[56:59], a[0:3], a[80:83], v[56:59]
    s_waitcnt vmcnt(12)
    s_add_u32 s54, s5, 8192
    v_fma_f32 v97, v97, v41, v153
    v_fma_f32 v98, v98, v42, v154
    v_mfma_f32_16x16x32_bf16 v[56:59], a[20:23], a[84:87], v[56:59]
    buffer_load_dwordx2 v[30:31], v8, s[32:35], s54 offen sc1
    v_mfma_f32_16x16x32_bf16 v[60:63], a[4:7], a[80:83], v[60:63]
    buffer_load_dwordx2 v[32:33], v8, s[32:35], s54 offen offset:256 sc1
    v_mfma_f32_16x16x32_bf16 v[60:63], a[24:27], a[84:87], v[60:63]
    buffer_load_dwordx2 v[34:35], v9, s[32:35], s54 offen sc1
    v_mfma_f32_16x16x32_bf16 v[64:67], a[8:11], a[80:83], v[64:67]
    v_fma_f32 v99, v99, v43, v155
    v_cvt_pk_bf16_f32 v96, v96, v97
    v_mfma_f32_16x16x32_bf16 v[64:67], a[28:31], a[84:87], v[64:67]
    v_cvt_pk_bf16_f32 v97, v98, v99
    s_add_u32 s53, s6, 0
    v_mfma_f32_16x16x32_bf16 v[68:71], a[12:15], a[80:83], v[68:71]
    buffer_store_dwordx2 v[96:97], v15, s[36:39], s53 offen
    v_mfma_f32_16x16x32_bf16 v[68:71], a[32:35], a[84:87], v[68:71]
    s_waitcnt lgkmcnt(6)
    v_add_f32 v112, v112, v116
    v_add_f32 v113, v113, v117
    v_mfma_f32_16x16x32_bf16 v[72:75], a[16:19], a[80:83], v[72:75]
    v_add_f32 v114, v114, v118
    v_add_f32 v115, v115, v119
    v_mfma_f32_16x16x32_bf16 v[72:75], a[36:39], a[84:87], v[72:75]
    s_waitcnt lgkmcnt(4) vmcnt(15)
    v_add_f32 v120, v120, v124
    v_add_f32 v121, v121, v125
    v_mfma_f32_16x16x32_bf16 v[76:79], v[184:187], a[88:91], 0
    s_waitcnt vmcnt(14)
    v_add_f32 v122, v122, v126
    v_add_f32 v123, v123, v127
    v_mfma_f32_16x16x32_bf16 v[76:79], v[204:207], a[92:95], v[76:79]
    v_add_f32 v112, v112, v120
    v_add_f32 v113, v113, v121
    v_mfma_f32_16x16x32_bf16 v[80:83], v[188:191], a[88:91], 0
    v_add_f32 v114, v114, v122
    v_add_f32 v115, v115, v123
    v_mfma_f32_16x16x32_bf16 v[80:83], v[208:211], a[92:95], v[80:83]
    v_fma_f32 v112, v112, v40, v156
    v_fma_f32 v113, v113, v41, v157
    v_mfma_f32_16x16x32_bf16 v[84:87], v[192:195], a[88:91], 0
    v_fma_f32 v114, v114, v42, v158
    v_fma_f32 v115, v115, v43, v159
    v_mfma_f32_16x16x32_bf16 v[84:87], v[212:215], a[92:95], v[84:87]
    v_cvt_pk_bf16_f32 v112, v112, v113
    v_cvt_pk_bf16_f32 v113, v114, v115
    v_mfma_f32_16x16x32_bf16 v[88:91], v[196:199], a[88:91], 0
    s_add_u32 s53, s6, 40960
    v_mfma_f32_16x16x32_bf16 v[88:91], v[216:219], a[92:95], v[88:91]
    buffer_store_dwordx2 v[112:113], v15, s[36:39], s53 offen
    v_mfma_f32_16x16x32_bf16 v[92:95], v[200:203], a[88:91], 0
    s_waitcnt lgkmcnt(2)
    v_add_f32 v164, v164, v168
    v_add_f32 v165, v165, v169
    v_mfma_f32_16x16x32_bf16 v[92:95], v[220:223], a[92:95], v[92:95]
    s_waitcnt vmcnt(14)
    v_add_f32 v166, v166, v170
    v_add_f32 v167, v167, v171
    v_mfma_f32_16x16x32_bf16 v[76:79], v[224:227], a[96:99], v[76:79]
    s_waitcnt lgkmcnt(0) vmcnt(13)
    v_add_f32 v172, v172, v176
    v_add_f32 v173, v173, v177
    v_mfma_f32_16x16x32_bf16 v[76:79], v[244:247], a[100:103], v[76:79]
    v_add_f32 v174, v174, v178
    v_add_f32 v175, v175, v179
    v_mfma_f32_16x16x32_bf16 v[80:83], v[228:231], a[96:99], v[80:83]
    v_add_f32 v164, v164, v172
    v_add_f32 v165, v165, v173
    v_mfma_f32_16x16x32_bf16 v[80:83], v[248:251], a[100:103], v[80:83]
    v_add_f32 v166, v166, v174
    v_add_f32 v167, v167, v175
    v_mfma_f32_16x16x32_bf16 v[84:87], v[232:235], a[96:99], v[84:87]
    v_fma_f32 v164, v164, v44, v160
    v_fma_f32 v165, v165, v45, v161
    v_mfma_f32_16x16x32_bf16 v[84:87], v[252:255], a[100:103], v[84:87]
    v_fma_f32 v166, v166, v46, v162
    v_fma_f32 v167, v167, v47, v163
    v_mfma_f32_16x16x32_bf16 v[88:91], v[236:239], a[96:99], v[88:91]
    v_cvt_pk_bf16_f32 v164, v164, v165
    v_cvt_pk_bf16_f32 v165, v166, v167
    v_mfma_f32_16x16x32_bf16 v[88:91], a[240:243], a[100:103], v[88:91]
    s_add_u32 s53, s6, 0
    v_mfma_f32_16x16x32_bf16 v[92:95], v[240:243], a[96:99], v[92:95]
    buffer_store_dwordx2 v[164:165], v16, s[36:39], s53 offen
    v_mfma_f32_16x16x32_bf16 v[92:95], a[244:247], a[100:103], v[92:95]
    s_waitcnt vmcnt(13)
    v_add_u32 v20, 81920, v20
    v_add_u32 v22, 81920, v22
    v_mfma_f32_16x16x32_bf16 v[76:79], a[248:251], a[104:107], v[76:79]
    s_waitcnt vmcnt(12)
    v_add_u32 v21, 81920, v21
    v_add_u32 v14, 81920, v14
    v_mfma_f32_16x16x32_bf16 v[76:79], a[140:143], a[108:111], v[76:79]
    ds_write_b128 v20, v[56:59] offset:0
    v_mfma_f32_16x16x32_bf16 v[80:83], a[252:255], a[104:107], v[80:83]
    v_mfma_f32_16x16x32_bf16 v[80:83], a[144:147], a[108:111], v[80:83]
    ds_write_b128 v20, v[60:63] offset:1024
    v_mfma_f32_16x16x32_bf16 v[84:87], a[128:131], a[104:107], v[84:87]
    v_mfma_f32_16x16x32_bf16 v[84:87], a[148:151], a[108:111], v[84:87]
    ds_write_b128 v20, v[64:67] offset:2048
    v_mfma_f32_16x16x32_bf16 v[88:91], a[132:135], a[104:107], v[88:91]
    v_mfma_f32_16x16x32_bf16 v[88:91], a[152:155], a[108:111], v[88:91]
    ds_write_b128 v20, v[68:71] offset:3072
    v_mfma_f32_16x16x32_bf16 v[92:95], a[136:139], a[104:107], v[92:95]
    v_mfma_f32_16x16x32_bf16 v[92:95], a[156:159], a[108:111], v[92:95]
    s_waitcnt vmcnt(11)
    ds_write_b128 v20, v[72:75] offset:4096
    v_mfma_f32_16x16x32_bf16 v[76:79], a[160:163], a[112:115], v[76:79]
    s_waitcnt vmcnt(10)
    v_mfma_f32_16x16x32_bf16 v[76:79], a[180:183], a[116:119], v[76:79]
    s_waitcnt vmcnt(9)
    v_mfma_f32_16x16x32_bf16 v[76:79], a[200:203], a[120:123], v[76:79]
    s_waitcnt vmcnt(8)
    v_mfma_f32_16x16x32_bf16 v[76:79], a[220:223], a[124:127], v[76:79]
    s_waitcnt vmcnt(7)
    v_mfma_f32_16x16x32_bf16 v[76:79], a[0:3], v[136:139], v[76:79]
    s_waitcnt vmcnt(6)
    v_mfma_f32_16x16x32_bf16 v[76:79], a[20:23], v[140:143], v[76:79]
    s_waitcnt vmcnt(5)
    ds_bpermute_b32 v30, v17, v30
    v_mfma_f32_16x16x32_bf16 v[80:83], a[164:167], a[112:115], v[80:83]
    ds_bpermute_b32 v31, v17, v31
    v_mfma_f32_16x16x32_bf16 v[80:83], a[184:187], a[116:119], v[80:83]
    s_waitcnt vmcnt(4)
    ds_bpermute_b32 v32, v17, v32
    v_mfma_f32_16x16x32_bf16 v[80:83], a[204:207], a[120:123], v[80:83]
    s_waitcnt vmcnt(3)
    ds_bpermute_b32 v33, v17, v33
    v_lshlrev_b32 v160, 16, v34
    v_mfma_f32_16x16x32_bf16 v[80:83], a[224:227], a[124:127], v[80:83]
    ds_write_b128 v22, v[76:79] offset:0
    v_and_b32 v161, 0xffff0000, v34
    v_mfma_f32_16x16x32_bf16 v[80:83], a[4:7], v[136:139], v[80:83]
    v_lshlrev_b32 v162, 16, v35
    v_and_b32 v163, 0xffff0000, v35
    v_mfma_f32_16x16x32_bf16 v[80:83], a[24:27], v[140:143], v[80:83]
    v_mul_f32 v160, v160, v148
    v_mul_f32 v161, v161, v149
    v_mfma_f32_16x16x32_bf16 v[84:87], a[168:171], a[112:115], v[84:87]
    v_mul_f32 v162, v162, v150
    v_mul_f32 v163, v163, v151
    v_mfma_f32_16x16x32_bf16 v[84:87], a[188:191], a[116:119], v[84:87]
    s_waitcnt lgkmcnt(4)
    v_lshlrev_b32 v152, 16, v30
    v_and_b32 v153, 0xffff0000, v30
    v_mfma_f32_16x16x32_bf16 v[84:87], a[208:211], a[120:123], v[84:87]
    s_waitcnt lgkmcnt(3)
    v_lshlrev_b32 v154, 16, v31
    v_and_b32 v155, 0xffff0000, v31
    v_mfma_f32_16x16x32_bf16 v[84:87], a[228:231], a[124:127], v[84:87]
    ds_write_b128 v22, v[80:83] offset:1024
    v_mul_f32 v152, v152, v144
    v_mfma_f32_16x16x32_bf16 v[84:87], a[8:11], v[136:139], v[84:87]
    v_mul_f32 v153, v153, v145
    v_mul_f32 v154, v154, v146
    v_mfma_f32_16x16x32_bf16 v[84:87], a[28:31], v[140:143], v[84:87]
    s_waitcnt lgkmcnt(3)
    v_mul_f32 v155, v155, v147
    v_lshlrev_b32 v156, 16, v32
    v_mfma_f32_16x16x32_bf16 v[88:91], a[172:175], a[112:115], v[88:91]
    s_waitcnt lgkmcnt(2)
    v_and_b32 v157, 0xffff0000, v32
    v_lshlrev_b32 v158, 16, v33
    v_mfma_f32_16x16x32_bf16 v[88:91], a[192:195], a[116:119], v[88:91]
    v_and_b32 v159, 0xffff0000, v33
    v_mul_f32 v156, v156, v144
    v_mfma_f32_16x16x32_bf16 v[88:91], a[212:215], a[120:123], v[88:91]
    v_mul_f32 v157, v157, v145
    v_mul_f32 v158, v158, v146
    v_mfma_f32_16x16x32_bf16 v[88:91], a[232:235], a[124:127], v[88:91]
    ds_write_b128 v22, v[84:87] offset:2048
    v_mul_f32 v159, v159, v147
    v_mfma_f32_16x16x32_bf16 v[88:91], a[12:15], v[136:139], v[88:91]
    v_mfma_f32_16x16x32_bf16 v[88:91], a[32:35], v[140:143], v[88:91]
    v_mfma_f32_16x16x32_bf16 v[92:95], a[176:179], a[112:115], v[92:95]
    v_mfma_f32_16x16x32_bf16 v[92:95], a[196:199], a[116:119], v[92:95]
    v_mfma_f32_16x16x32_bf16 v[92:95], a[216:219], a[120:123], v[92:95]
    v_mfma_f32_16x16x32_bf16 v[92:95], a[236:239], a[124:127], v[92:95]
    s_nop 3
    ds_write_b128 v22, v[88:91] offset:3072
    v_mfma_f32_16x16x32_bf16 v[92:95], a[16:19], v[136:139], v[92:95]
    v_mfma_f32_16x16x32_bf16 v[92:95], a[36:39], v[140:143], v[92:95]
    s_nop 7
    ds_write_b128 v22, v[92:95] offset:4096
    s_waitcnt lgkmcnt(0)
    s_barrier
    ds_read_b128 v[96:99], v21 offset:0
    ds_read_b128 v[100:103], v21 offset:5120
    ds_read_b128 v[104:107], v21 offset:10240
    ds_read_b128 v[108:111], v21 offset:15360
    ds_read_b128 v[112:115], v21 offset:20480
    ds_read_b128 v[116:119], v21 offset:25600
    ds_read_b128 v[120:123], v21 offset:30720
    ds_read_b128 v[124:127], v21 offset:35840
    ds_read_b128 v[164:167], v14 offset:0
    ds_read_b128 v[168:171], v14 offset:5120
    ds_read_b128 v[172:175], v14 offset:10240
    ds_read_b128 v[176:179], v14 offset:15360
    s_waitcnt lgkmcnt(10)
    v_pk_add_f32 v[96:97], v[96:97], v[100:101]
    s_waitcnt lgkmcnt(8)
    v_pk_add_f32 v[104:105], v[104:105], v[108:109]
    v_pk_add_f32 v[98:99], v[98:99], v[102:103]
    v_pk_add_f32 v[106:107], v[106:107], v[110:111]
    v_pk_add_f32 v[96:97], v[96:97], v[104:105]
    v_pk_add_f32 v[98:99], v[98:99], v[106:107]
    v_pk_fma_f32 v[96:97], v[96:97], v[40:41], v[152:153]
    v_pk_fma_f32 v[98:99], v[98:99], v[42:43], v[154:155]
    v_cvt_pk_bf16_f32 v96, v96, v97
    v_cvt_pk_bf16_f32 v97, v98, v99
    s_add_u32 s53, s6, 1310720
    buffer_store_dwordx2 v[96:97], v15, s[36:39], s53 offen
    s_waitcnt lgkmcnt(6)
    v_pk_add_f32 v[112:113], v[112:113], v[116:117]
    s_waitcnt lgkmcnt(4)
    v_pk_add_f32 v[120:121], v[120:121], v[124:125]
    v_pk_add_f32 v[114:115], v[114:115], v[118:119]
    v_pk_add_f32 v[122:123], v[122:123], v[126:127]
    v_pk_add_f32 v[112:113], v[112:113], v[120:121]
    v_pk_add_f32 v[114:115], v[114:115], v[122:123]
    v_pk_fma_f32 v[112:113], v[112:113], v[40:41], v[156:157]
    v_pk_fma_f32 v[114:115], v[114:115], v[42:43], v[158:159]
    v_cvt_pk_bf16_f32 v112, v112, v113
    v_cvt_pk_bf16_f32 v113, v114, v115
    s_add_u32 s53, s6, 1351680
    buffer_store_dwordx2 v[112:113], v15, s[36:39], s53 offen
    s_waitcnt lgkmcnt(2)
    v_pk_add_f32 v[164:165], v[164:165], v[168:169]
    s_waitcnt lgkmcnt(0)
    v_pk_add_f32 v[172:173], v[172:173], v[176:177]
    v_pk_add_f32 v[166:167], v[166:167], v[170:171]
    v_pk_add_f32 v[174:175], v[174:175], v[178:179]
    v_pk_add_f32 v[164:165], v[164:165], v[172:173]
    v_pk_add_f32 v[166:167], v[166:167], v[174:175]
    v_pk_fma_f32 v[164:165], v[164:165], v[44:45], v[160:161]
    v_pk_fma_f32 v[166:167], v[166:167], v[46:47], v[162:163]
    v_cvt_pk_bf16_f32 v164, v164, v165
    v_cvt_pk_bf16_f32 v165, v166, v167
    s_add_u32 s53, s6, 1310720
    buffer_store_dwordx2 v[164:165], v16, s[36:39], s53 offen
Lfin:
    s_endpgm
LW:
    s_sub_u32 s45, s2, 160
    s_mul_i32 s51, s45, 3
    s_sub_u32 s51, s51, 160
    s_cmp_lt_u32 s45, 80
    s_cselect_b32 s98, s45, s51
    s_lshl_b32 s51, s98, 4
    v_lshrrev_b32 v241, 4, v0
    v_add_u32 v242, s51, v241
    v_mul_u32_u24 v231, 1280, v242
    v_and_b32 v243, 15, v0
    v_lshl_add_u32 v231, v243, 4, v231
    v_and_b32 v238, 7, v0
    s_waitcnt lgkmcnt(0)
    s_load_dword s46, s[30:31], 0
    global_load_dwordx4 v[24:27], v231, s[4:5] offset:0 nt
    global_load_dwordx4 v[28:31], v231, s[4:5] offset:256 nt
    global_load_dwordx4 v[32:35], v231, s[4:5] offset:512 nt
    global_load_dwordx4 v[36:39], v231, s[4:5] offset:768 nt
    global_load_dwordx4 v[40:43], v231, s[4:5] offset:1024 nt
    s_mov_b32 s32, s30
    s_mov_b32 s33, s31
    s_mov_b32 s34, 22298624
    s_mov_b32 s35, 0x20000
    s_and_b32 s51, s49, 1
    s_lshl_b32 s51, s51, 3
    s_lshr_b32 s56, s50, 2
    s_add_u32 s51, s51, s56
    s_lshl_b32 s51, s51, 4
    s_lshr_b32 s56, s49, 1
    s_lshl_b32 s56, s56, 2
    s_add_u32 s51, s51, s56
    s_and_b32 s56, s50, 3
    s_add_u32 s51, s51, s56
    s_lshl_b32 s51, s51, 7
    s_lshl_b32 s56, s45, 7
    v_mov_b32 v140, 0x80000000
    v_lshrrev_b32 v141, 3, v0
    s_add_u32 s57, s56, 22040576
    v_cmp_eq_u32 vcc, 0, v141
    v_mov_b32 v142, s57
    s_nop 0
    v_cndmask_b32 v140, v140, v142, vcc
    s_add_u32 s57, s56, 22061056
    v_cmp_eq_u32 vcc, 1, v141
    v_mov_b32 v142, s57
    s_nop 0
    v_cndmask_b32 v140, v140, v142, vcc
    s_add_u32 s57, s56, 22073344
    v_cmp_eq_u32 vcc, 2, v141
    v_mov_b32 v142, s57
    s_nop 0
    v_cndmask_b32 v140, v140, v142, vcc
    s_add_u32 s57, s51, 22126592
    v_cmp_eq_u32 vcc, 3, v141
    v_mov_b32 v142, s57
    s_nop 0
    v_cndmask_b32 v140, v140, v142, vcc
    s_add_u32 s57, s51, 22159360
    v_cmp_eq_u32 vcc, 4, v141
    v_mov_b32 v142, s57
    s_nop 0
    v_cndmask_b32 v140, v140, v142, vcc
    s_add_u32 s57, s51, 22192128
    v_cmp_eq_u32 vcc, 5, v141
    v_mov_b32 v142, s57
    s_nop 0
    v_cndmask_b32 v140, v140, v142, vcc
    s_add_u32 s57, s51, 22261760
    v_cmp_eq_u32 vcc, 6, v141
    v_mov_b32 v142, s57
    s_nop 0
    v_cndmask_b32 v140, v140, v142, vcc
    s_add_u32 s57, s51, 21495808
    v_cmp_eq_u32 vcc, 7, v141
    v_mov_b32 v142, s57
    s_nop 0
    v_cndmask_b32 v140, v140, v142, vcc
    s_add_u32 s57, s51, 21528576
    v_cmp_eq_u32 vcc, 8, v141
    v_mov_b32 v142, s57
    s_nop 0
    v_cndmask_b32 v140, v140, v142, vcc
    v_and_b32 v141, 7, v0
    v_lshl_add_u32 v140, v141, 4, v140
    v_mov_b32 v144, 0
    v_mov_b32 v145, 0
    v_mov_b32 v146, 0
    v_mov_b32 v147, 0
    buffer_store_dwordx4 v[144:147], v140, s[32:35], 0 offen sc1
    s_mov_b32 s36, s18
    s_mov_b32 s37, s19
    s_mov_b32 s38, 1966080
    s_mov_b32 s39, 0x20000
    s_mov_b32 s40, s20
    s_mov_b32 s41, s21
    s_mov_b32 s42, 1966080
    s_mov_b32 s43, 0x20000
    v_lshrrev_b32 v236, 4, v1
    s_lshr_b32 s51, s45, 2
    s_lshl_b32 s51, s51, 2
    s_add_u32 s51, s51, s44
    s_mul_i32 s51, s51, 24576
    s_and_b32 s56, s45, 3
    s_mul_i32 s56, s56, 768
    s_add_u32 s51, s51, s56
    v_mul_u32_u24 v237, 3072, v236
    v_add_u32 v237, s51, v237
    v_lshlrev_b32 v236, 1, v236
    v_xor_b32 v236, v236, v243
    v_lshl_add_u32 v224, v236, 4, v237
    v_xor_b32 v225, 16, v224
    v_xor_b32 v226, 128, v224
    v_add_u32 v226, 12288, v226
    v_xor_b32 v227, 16, v226
    s_movk_i32 s80, 256
    s_movk_i32 s81, 512
    v_lshlrev_b32 v242, 3, v242
    v_mov_b32 v237, 0x80000000
    v_cmp_eq_u32 vcc, 0, v243
    s_nop 1
    v_cndmask_b32 v232, v237, v242, vcc
    v_lshrrev_b32 v237, 1, v241
    v_xor_b32 v237, v237, v238
    v_lshlrev_b32 v237, 4, v237
    v_and_b32 v239, 1, v241
    v_lshl_add_u32 v237, v239, 3, v237
    v_lshl_add_u32 v233, v243, 8, v237
    s_and_b32 s51, s44, 1
    s_lshl_b32 s51, s51, 2
    v_lshrrev_b32 v237, 4, v1
    v_add_u32 v237, s51, v237
    v_xor_b32 v237, v237, v1
    s_mul_i32 s51, s44, 5120
    v_lshl_add_u32 v234, v237, 4, s51
    v_lshrrev_b32 v237, 3, v1
    v_lshlrev_b32 v237, 14, v237
    v_lshl_add_u32 v235, v238, 4, v237
    s_mul_i32 s51, s44, 655360
    s_lshl_b32 s98, s98, 7
    s_add_u32 s98, s98, s51
    s_add_u32 s98, s98, 3670016
    v_lshrrev_b32 v236, 2, v1
    v_bfe_u32 v237, v1, 1, 4
    v_lshlrev_b32 v237, 4, v237
    v_lshl_add_u32 v237, v236, 8, v237
    v_and_b32 v236, 1, v1
    v_lshl_add_u32 v237, v236, 3, v237
    v_bfe_u32 v239, v1, 1, 1
    v_mul_u32_u24 v239, 24576, v239
    v_add_u32 v228, v237, v239
    v_bfe_u32 v237, v1, 1, 2
    v_lshl_add_u32 v236, v237, 2, v236
    v_bfe_u32 v237, v1, 3, 1
    v_lshl_add_u32 v236, v237, 1, v236
    v_and_b32 v237, 48, v1
    v_add_u32 v236, v236, v237
    v_lshlrev_b32 v229, 4, v236
    s_and_b32 s51, s45, 3
    s_lshl_b32 s51, s51, 2
    s_add_u32 s51, s51, s44
    s_mul_i32 s51, s51, 245760
    s_lshr_b32 s56, s45, 2
    s_mul_i32 s56, s56, 3072
    s_add_u32 s51, s51, s56
    s_add_u32 s84, s51, 8912896
    s_and_b32 s54, s49, 1
    s_mul_i32 s54, s54, 3
    s_lshr_b32 s51, s50, 2
    s_add_u32 s54, s54, s51
    s_sub_u32 s54, s54, 5
    s_and_b32 s55, s54, 3
    s_waitcnt lgkmcnt(0)
    s_add_u32 s46, s46, 2654435769
    s_or_b32 s46, s46, 1
    v_mov_b32 v2, s46
    s_lshl_b32 s51, s45, 1
    s_add_u32 s51, s51, 0
    s_mul_i32 s56, s51, 43691
    s_lshr_b32 s56, s56, 17
    s_mul_i32 s57, s56, 3
    s_sub_u32 s57, s51, s57
    s_mul_i32 s56, s56, 24
    s_lshl_b32 s51, s57, 1
    s_cmp_eq_u32 s57, 2
    s_cselect_b32 s51, 16, s51
    s_cselect_b32 s88, 2, 4
    s_add_u32 s86, s56, s51
    s_lshl_b32 s51, s45, 1
    s_add_u32 s51, s51, 1
    s_mul_i32 s56, s51, 43691
    s_lshr_b32 s56, s56, 17
    s_mul_i32 s57, s56, 3
    s_sub_u32 s57, s51, s57
    s_mul_i32 s56, s56, 24
    s_lshl_b32 s51, s57, 1
    s_cmp_eq_u32 s57, 2
    s_cselect_b32 s51, 16, s51
    s_cselect_b32 s89, 2, 4
    s_add_u32 s87, s56, s51
    v_mov_b32 v250, s86
    v_mov_b32 v251, s87
    v_mov_b32 v252, s88
    v_mov_b32 v253, s89
    v_add_u32 v236, 0, v0
    v_mul_u32_u24 v237, 52429, v236
    v_lshrrev_b32 v237, 22, v237
    v_mul_u32_u24 v239, 80, v237
    v_sub_u32 v236, v236, v239
    v_cmp_lt_u32 vcc, 7, v237
    v_bfe_u32 v239, v237, 1, 2
    v_and_b32 v237, 1, v237
    v_cndmask_b32 v240, v250, v251, vcc
    v_cndmask_b32 v241, v252, v253, vcc
    v_mad_u32_u24 v237, v239, v241, v237
    v_add_u32 v237, v237, v240
    v_mul_u32_u24 v237, 1280, v237
    v_lshl_add_u32 v216, v236, 4, v237
    v_add_u32 v236, 256, v0
    v_mul_u32_u24 v237, 52429, v236
    v_lshrrev_b32 v237, 22, v237
    v_mul_u32_u24 v239, 80, v237
    v_sub_u32 v236, v236, v239
    v_cmp_lt_u32 vcc, 7, v237
    v_bfe_u32 v239, v237, 1, 2
    v_and_b32 v237, 1, v237
    v_cndmask_b32 v240, v250, v251, vcc
    v_cndmask_b32 v241, v252, v253, vcc
    v_mad_u32_u24 v237, v239, v241, v237
    v_add_u32 v237, v237, v240
    v_mul_u32_u24 v237, 1280, v237
    v_lshl_add_u32 v217, v236, 4, v237
    v_add_u32 v236, 512, v0
    v_mul_u32_u24 v237, 52429, v236
    v_lshrrev_b32 v237, 22, v237
    v_mul_u32_u24 v239, 80, v237
    v_sub_u32 v236, v236, v239
    v_cmp_lt_u32 vcc, 7, v237
    v_bfe_u32 v239, v237, 1, 2
    v_and_b32 v237, 1, v237
    v_cndmask_b32 v240, v250, v251, vcc
    v_cndmask_b32 v241, v252, v253, vcc
    v_mad_u32_u24 v237, v239, v241, v237
    v_add_u32 v237, v237, v240
    v_mul_u32_u24 v237, 1280, v237
    v_lshl_add_u32 v218, v236, 4, v237
    v_add_u32 v236, 768, v0
    v_mul_u32_u24 v237, 52429, v236
    v_lshrrev_b32 v237, 22, v237
    v_mul_u32_u24 v239, 80, v237
    v_sub_u32 v236, v236, v239
    v_cmp_lt_u32 vcc, 7, v237
    v_bfe_u32 v239, v237, 1, 2
    v_and_b32 v237, 1, v237
    v_cndmask_b32 v240, v250, v251, vcc
    v_cndmask_b32 v241, v252, v253, vcc
    v_mad_u32_u24 v237, v239, v241, v237
    v_add_u32 v237, v237, v240
    v_mul_u32_u24 v237, 1280, v237
    v_lshl_add_u32 v219, v236, 4, v237
    v_add_u32 v236, 1024, v0
    v_mul_u32_u24 v237, 52429, v236
    v_lshrrev_b32 v237, 22, v237
    v_mul_u32_u24 v239, 80, v237
    v_sub_u32 v236, v236, v239
    v_cmp_lt_u32 vcc, 7, v237
    v_bfe_u32 v239, v237, 1, 2
    v_and_b32 v237, 1, v237
    v_cndmask_b32 v240, v250, v251, vcc
    v_cndmask_b32 v241, v252, v253, vcc
    v_mad_u32_u24 v237, v239, v241, v237
    v_add_u32 v237, v237, v240
    v_mul_u32_u24 v237, 1280, v237
    v_lshl_add_u32 v220, v236, 4, v237
    s_cmp_ge_u32 s45, 80
    s_cbranch_scc1 LWa
    s_lshl_b32 s56, s44, 11
    s_add_u32 m0, s56, 0
    s_nop 0
    buffer_load_dwordx4 v224, s[36:39], 0 offen nt lds
    s_add_u32 m0, s56, 8192
    s_nop 0
    buffer_load_dwordx4 v224, s[36:39], s80 offen nt lds
    s_add_u32 m0, s56, 16384
    s_nop 0
    buffer_load_dwordx4 v224, s[36:39], s81 offen nt lds
    s_add_u32 m0, s56, 24576
    s_nop 0
    buffer_load_dwordx4 v225, s[40:43], 0 offen nt lds
    s_add_u32 m0, s56, 32768
    s_nop 0
    buffer_load_dwordx4 v225, s[40:43], s80 offen nt lds
    s_add_u32 m0, s56, 40960
    s_nop 0
    buffer_load_dwordx4 v225, s[40:43], s81 offen nt lds
    s_add_u32 m0, s56, 1024
    s_nop 0
    buffer_load_dwordx4 v226, s[36:39], 0 offen nt lds
    s_add_u32 m0, s56, 9216
    s_nop 0
    buffer_load_dwordx4 v226, s[36:39], s80 offen nt lds
    s_add_u32 m0, s56, 17408
    s_nop 0
    buffer_load_dwordx4 v226, s[36:39], s81 offen nt lds
    s_add_u32 m0, s56, 25600
    s_nop 0
    buffer_load_dwordx4 v227, s[40:43], 0 offen nt lds
    s_add_u32 m0, s56, 33792
    s_nop 0
    buffer_load_dwordx4 v227, s[40:43], s80 offen nt lds
    s_add_u32 m0, s56, 41984
    s_nop 0
    buffer_load_dwordx4 v227, s[40:43], s81 offen nt lds
    s_branch LWb
LWa:
    v_add_u32 v231, 20480, v231
    global_load_dwordx4 v[44:47], v231, s[4:5] offset:0 nt
    global_load_dwordx4 v[48:51], v231, s[4:5] offset:256 nt
    global_load_dwordx4 v[52:55], v231, s[4:5] offset:512 nt
    global_load_dwordx4 v[56:59], v231, s[4:5] offset:768 nt
    global_load_dwordx4 v[60:63], v231, s[4:5] offset:1024 nt
    v_add_u32 v231, 20480, v231
    global_load_dwordx4 v[64:67], v231, s[4:5] offset:0 nt
    global_load_dwordx4 v[68:71], v231, s[4:5] offset:256 nt
    global_load_dwordx4 v[72:75], v231, s[4:5] offset:512 nt
    global_load_dwordx4 v[76:79], v231, s[4:5] offset:768 nt
    global_load_dwordx4 v[80:83], v231, s[4:5] offset:1024 nt
LWb:
    s_waitcnt vmcnt(11)
    v_add_u32 v236, 73728, v233
    ds_write_b64 v236, v[24:25] offset:0
    ds_write_b64 v236, v[26:27] offset:128
    ds_write_b64 v236, v[28:29] offset:4096
    ds_write_b64 v236, v[30:31] offset:4224
    ds_write_b64 v236, v[32:33] offset:8192
    ds_write_b64 v236, v[34:35] offset:8320
    ds_write_b64 v236, v[36:37] offset:12288
    ds_write_b64 v236, v[38:39] offset:12416
    ds_write_b64 v236, v[40:41] offset:16384
    ds_write_b64 v236, v[42:43] offset:16512
    s_waitcnt lgkmcnt(0)
    s_barrier
    v_add_u32 v236, 73728, v234
    v_xor_b32 v237, 64, v236
    ds_read_b128 v[84:87], v236 offset:0
    ds_read_b128 v[88:91], v237 offset:1024
    ds_read_b128 v[92:95], v236 offset:2048
    ds_read_b128 v[96:99], v237 offset:3072
    ds_read_b128 v[100:103], v236 offset:4096
    s_add_u32 s51, s98, 0
    s_waitcnt lgkmcnt(4)
    buffer_store_dwordx4 v[84:87], v235, s[32:35], s51 offen sc1
    v_mov_b32 v239, 0x3f803f80
    v_dot2_f32_bf16 v136, v24, v239, 0
    v_dot2_f32_bf16 v138, v24, v24, 0
    v_dot2_f32_bf16 v137, v25, v239, 0
    v_dot2_f32_bf16 v139, v25, v25, 0
    v_dot2_f32_bf16 v136, v26, v239, v136
    v_dot2_f32_bf16 v138, v26, v26, v138
    v_dot2_f32_bf16 v137, v27, v239, v137
    v_dot2_f32_bf16 v139, v27, v27, v139
    v_dot2_f32_bf16 v136, v28, v239, v136
    v_dot2_f32_bf16 v138, v28, v28, v138
    v_dot2_f32_bf16 v137, v29, v239, v137
    s_add_u32 s51, s98, 131072
    s_waitcnt lgkmcnt(3)
    buffer_store_dwordx4 v[88:91], v235, s[32:35], s51 offen sc1
    v_dot2_f32_bf16 v139, v29, v29, v139
    v_dot2_f32_bf16 v136, v30, v239, v136
    v_dot2_f32_bf16 v138, v30, v30, v138
    v_dot2_f32_bf16 v137, v31, v239, v137
    v_dot2_f32_bf16 v139, v31, v31, v139
    v_dot2_f32_bf16 v136, v32, v239, v136
    v_dot2_f32_bf16 v138, v32, v32, v138
    v_dot2_f32_bf16 v137, v33, v239, v137
    v_dot2_f32_bf16 v139, v33, v33, v139
    v_dot2_f32_bf16 v136, v34, v239, v136
    v_dot2_f32_bf16 v138, v34, v34, v138
    s_add_u32 s51, s98, 262144
    s_waitcnt lgkmcnt(2)
    buffer_store_dwordx4 v[92:95], v235, s[32:35], s51 offen sc1
    v_dot2_f32_bf16 v137, v35, v239, v137
    v_dot2_f32_bf16 v139, v35, v35, v139
    v_dot2_f32_bf16 v136, v36, v239, v136
    v_dot2_f32_bf16 v138, v36, v36, v138
    v_dot2_f32_bf16 v137, v37, v239, v137
    v_dot2_f32_bf16 v139, v37, v37, v139
    v_dot2_f32_bf16 v136, v38, v239, v136
    v_dot2_f32_bf16 v138, v38, v38, v138
    v_dot2_f32_bf16 v137, v39, v239, v137
    v_dot2_f32_bf16 v139, v39, v39, v139
    v_dot2_f32_bf16 v136, v40, v239, v136
    v_dot2_f32_bf16 v138, v40, v40, v138
    s_add_u32 s51, s98, 393216
    s_waitcnt lgkmcnt(1)
    buffer_store_dwordx4 v[96:99], v235, s[32:35], s51 offen sc1
    v_dot2_f32_bf16 v137, v41, v239, v137
    v_dot2_f32_bf16 v139, v41, v41, v139
    v_dot2_f32_bf16 v136, v42, v239, v136
    v_dot2_f32_bf16 v138, v42, v42, v138
    v_dot2_f32_bf16 v137, v43, v239, v137
    v_dot2_f32_bf16 v139, v43, v43, v139
    s_nop 1
    v_add_f32 v136, v136, v137
    v_add_f32 v138, v138, v139
    s_nop 0
    v_add_f32_dpp v136, v136, v136 row_ror:8 row_mask:0xf bank_mask:0xf
    v_add_f32_dpp v138, v138, v138 row_ror:8 row_mask:0xf bank_mask:0xf
    s_nop 0
    v_add_f32_dpp v136, v136, v136 row_ror:4 row_mask:0xf bank_mask:0xf
    s_add_u32 s51, s98, 524288
    s_waitcnt lgkmcnt(0)
    buffer_store_dwordx4 v[100:103], v235, s[32:35], s51 offen sc1
    v_add_f32_dpp v138, v138, v138 row_ror:4 row_mask:0xf bank_mask:0xf
    v_add_f32_dpp v136, v136, v136 row_ror:2 row_mask:0xf bank_mask:0xf
    s_nop 0
    v_add_f32_dpp v138, v138, v138 row_ror:2 row_mask:0xf bank_mask:0xf
    v_add_f32_dpp v136, v136, v136 row_ror:1 row_mask:0xf bank_mask:0xf
    s_nop 0
    v_add_f32_dpp v138, v138, v138 row_ror:1 row_mask:0xf bank_mask:0xf
    v_mul_f32 v136, 0x3acccccd, v136
    v_mul_f32 v138, 0x3acccccd, v138
    v_fma_f32 v138, -v136, v136, v138
    v_max_f32 v138, 0, v138
    v_add_f32 v138, 0x3727c5ac, v138
    v_rsq_f32 v138, v138
    s_mov_b32 s51, 262144
    v_mul_f32_e64 v139, -v136, v138
    buffer_store_dwordx2 v[138:139], v232, s[32:35], s51 offen sc1
    s_waitcnt vmcnt(6) lgkmcnt(0)
    s_cmp_ge_u32 s45, 80
    s_cbranch_scc1 LWq
    s_barrier
    s_mul_i32 s56, s44, 12
    s_add_u32 s51, s56, 0
    s_lshr_b32 s57, s51, 4
    s_lshl_b32 s57, s57, 13
    s_and_b32 s51, s51, 15
    s_lshl_b32 s51, s51, 4
    v_xor_b32 v236, s51, v228
    v_add_u32 v236, s57, v236
    ds_read_b64_tr_b16 v[148:149], v236 offset:0
    ds_read_b64_tr_b16 v[150:151], v236 offset:4096
    s_add_u32 s51, s56, 1
    s_lshr_b32 s57, s51, 4
    s_lshl_b32 s57, s57, 13
    s_and_b32 s51, s51, 15
    s_lshl_b32 s51, s51, 4
    v_xor_b32 v237, s51, v228
    v_add_u32 v237, s57, v237
    ds_read_b64_tr_b16 v[152:153], v237 offset:0
    ds_read_b64_tr_b16 v[154:155], v237 offset:4096
    s_add_u32 s51, s56, 2
    s_lshr_b32 s57, s51, 4
    s_lshl_b32 s57, s57, 13
    s_and_b32 s51, s51, 15
    s_lshl_b32 s51, s51, 4
    v_xor_b32 v236, s51, v228
    v_add_u32 v236, s57, v236
    ds_read_b64_tr_b16 v[156:157], v236 offset:0
    ds_read_b64_tr_b16 v[158:159], v236 offset:4096
    s_add_u32 s51, s56, 3
    s_lshr_b32 s57, s51, 4
    s_lshl_b32 s57, s57, 13
    s_and_b32 s51, s51, 15
    s_lshl_b32 s51, s51, 4
    v_xor_b32 v237, s51, v228
    v_add_u32 v237, s57, v237
    ds_read_b64_tr_b16 v[160:161], v237 offset:0
    ds_read_b64_tr_b16 v[162:163], v237 offset:4096
    s_add_u32 s51, s56, 4
    s_lshr_b32 s57, s51, 4
    s_lshl_b32 s57, s57, 13
    s_and_b32 s51, s51, 15
    s_lshl_b32 s51, s51, 4
    v_xor_b32 v236, s51, v228
    v_add_u32 v236, s57, v236
    ds_read_b64_tr_b16 v[164:165], v236 offset:0
    ds_read_b64_tr_b16 v[166:167], v236 offset:4096
    s_add_u32 s51, s56, 5
    s_lshr_b32 s57, s51, 4
    s_lshl_b32 s57, s57, 13
    s_and_b32 s51, s51, 15
    s_lshl_b32 s51, s51, 4
    v_xor_b32 v237, s51, v228
    v_add_u32 v237, s57, v237
    ds_read_b64_tr_b16 v[168:169], v237 offset:0
    ds_read_b64_tr_b16 v[170:171], v237 offset:4096
    s_add_u32 s51, s56, 6
    s_lshr_b32 s57, s51, 4
    s_lshl_b32 s57, s57, 13
    s_and_b32 s51, s51, 15
    s_lshl_b32 s51, s51, 4
    v_xor_b32 v236, s51, v228
    v_add_u32 v236, s57, v236
    ds_read_b64_tr_b16 v[172:173], v236 offset:0
    ds_read_b64_tr_b16 v[174:175], v236 offset:4096
    s_add_u32 s51, s56, 7
    s_lshr_b32 s57, s51, 4
    s_lshl_b32 s57, s57, 13
    s_and_b32 s51, s51, 15
    s_lshl_b32 s51, s51, 4
    v_xor_b32 v237, s51, v228
    v_add_u32 v237, s57, v237
    ds_read_b64_tr_b16 v[176:177], v237 offset:0
    ds_read_b64_tr_b16 v[178:179], v237 offset:4096
    s_add_u32 s51, s56, 8
    s_lshr_b32 s57, s51, 4
    s_lshl_b32 s57, s57, 13
    s_and_b32 s51, s51, 15
    s_lshl_b32 s51, s51, 4
    v_xor_b32 v236, s51, v228
    v_add_u32 v236, s57, v236
    ds_read_b64_tr_b16 v[180:181], v236 offset:0
    ds_read_b64_tr_b16 v[182:183], v236 offset:4096
    s_add_u32 s51, s56, 9
    s_lshr_b32 s57, s51, 4
    s_lshl_b32 s57, s57, 13
    s_and_b32 s51, s51, 15
    s_lshl_b32 s51, s51, 4
    v_xor_b32 v237, s51, v228
    v_add_u32 v237, s57, v237
    ds_read_b64_tr_b16 v[184:185], v237 offset:0
    ds_read_b64_tr_b16 v[186:187], v237 offset:4096
    s_add_u32 s51, s56, 10
    s_lshr_b32 s57, s51, 4
    s_lshl_b32 s57, s57, 13
    s_and_b32 s51, s51, 15
    s_lshl_b32 s51, s51, 4
    v_xor_b32 v236, s51, v228
    v_add_u32 v236, s57, v236
    ds_read_b64_tr_b16 v[188:189], v236 offset:0
    ds_read_b64_tr_b16 v[190:191], v236 offset:4096
    s_add_u32 s51, s56, 11
    s_lshr_b32 s57, s51, 4
    s_lshl_b32 s57, s57, 13
    s_and_b32 s51, s51, 15
    s_lshl_b32 s51, s51, 4
    v_xor_b32 v237, s51, v228
    v_add_u32 v237, s57, v237
    ds_read_b64_tr_b16 v[192:193], v237 offset:0
    ds_read_b64_tr_b16 v[194:195], v237 offset:4096
    s_waitcnt vmcnt(0)
    s_barrier
    s_lshl_b32 s51, s45, 7
    s_add_u32 s51, s51, 22040576
    buffer_store_dword v2, v3, s[32:35], s51 offen sc1
    s_waitcnt lgkmcnt(15)
    buffer_store_dwordx4 v[148:151], v229, s[32:35], s84 offen offset:0 sc1
    s_waitcnt lgkmcnt(15)
    buffer_store_dwordx4 v[152:155], v229, s[32:35], s84 offen offset:1024 sc1
    s_waitcnt lgkmcnt(15)
    buffer_store_dwordx4 v[156:159], v229, s[32:35], s84 offen offset:2048 sc1
    s_add_u32 s84, s84, 61440
    s_waitcnt lgkmcnt(15)
    buffer_store_dwordx4 v[160:163], v229, s[32:35], s84 offen offset:0 sc1
    s_waitcnt lgkmcnt(14)
    buffer_store_dwordx4 v[164:167], v229, s[32:35], s84 offen offset:1024 sc1
    s_waitcnt lgkmcnt(12)
    buffer_store_dwordx4 v[168:171], v229, s[32:35], s84 offen offset:2048 sc1
    s_add_u32 s84, s84, 61440
    s_waitcnt lgkmcnt(10)
    buffer_store_dwordx4 v[172:175], v229, s[32:35], s84 offen offset:0 sc1
    s_waitcnt lgkmcnt(8)
    buffer_store_dwordx4 v[176:179], v229, s[32:35], s84 offen offset:1024 sc1
    s_waitcnt lgkmcnt(6)
    buffer_store_dwordx4 v[180:183], v229, s[32:35], s84 offen offset:2048 sc1
    s_add_u32 s84, s84, 61440
    s_waitcnt lgkmcnt(4)
    buffer_store_dwordx4 v[184:187], v229, s[32:35], s84 offen offset:0 sc1
    s_waitcnt lgkmcnt(2)
    buffer_store_dwordx4 v[188:191], v229, s[32:35], s84 offen offset:1024 sc1
    s_waitcnt lgkmcnt(0)
    buffer_store_dwordx4 v[192:195], v229, s[32:35], s84 offen offset:2048 sc1
    s_mov_b32 s53, 320
    s_branch LWj
LWq:
    v_add_u32 v236, 94208, v233
    ds_write_b64 v236, v[44:45] offset:0
    ds_write_b64 v236, v[46:47] offset:128
    ds_write_b64 v236, v[48:49] offset:4096
    ds_write_b64 v236, v[50:51] offset:4224
    ds_write_b64 v236, v[52:53] offset:8192
    ds_write_b64 v236, v[54:55] offset:8320
    ds_write_b64 v236, v[56:57] offset:12288
    ds_write_b64 v236, v[58:59] offset:12416
    ds_write_b64 v236, v[60:61] offset:16384
    ds_write_b64 v236, v[62:63] offset:16512
    v_add_u32 v236, 114688, v233
    ds_write_b64 v236, v[64:65] offset:0
    ds_write_b64 v236, v[66:67] offset:128
    ds_write_b64 v236, v[68:69] offset:4096
    ds_write_b64 v236, v[70:71] offset:4224
    ds_write_b64 v236, v[72:73] offset:8192
    ds_write_b64 v236, v[74:75] offset:8320
    ds_write_b64 v236, v[76:77] offset:12288
    ds_write_b64 v236, v[78:79] offset:12416
    ds_write_b64 v236, v[80:81] offset:16384
    ds_write_b64 v236, v[82:83] offset:16512
    s_waitcnt lgkmcnt(0)
    s_barrier
    v_add_u32 v236, 94208, v234
    v_xor_b32 v237, 64, v236
    ds_read_b128 v[84:87], v236 offset:0
    ds_read_b128 v[88:91], v237 offset:1024
    ds_read_b128 v[92:95], v236 offset:2048
    ds_read_b128 v[96:99], v237 offset:3072
    ds_read_b128 v[100:103], v236 offset:4096
    s_add_u32 s51, s98, 128
    s_waitcnt lgkmcnt(4)
    buffer_store_dwordx4 v[84:87], v235, s[32:35], s51 offen sc1
    v_mov_b32 v239, 0x3f803f80
    v_dot2_f32_bf16 v136, v44, v239, 0
    v_dot2_f32_bf16 v138, v44, v44, 0
    v_dot2_f32_bf16 v137, v45, v239, 0
    v_dot2_f32_bf16 v139, v45, v45, 0
    v_dot2_f32_bf16 v136, v46, v239, v136
    v_dot2_f32_bf16 v138, v46, v46, v138
    v_dot2_f32_bf16 v137, v47, v239, v137
    v_dot2_f32_bf16 v139, v47, v47, v139
    v_dot2_f32_bf16 v136, v48, v239, v136
    v_dot2_f32_bf16 v138, v48, v48, v138
    v_dot2_f32_bf16 v137, v49, v239, v137
    s_add_u32 s51, s98, 131200
    s_waitcnt lgkmcnt(3)
    buffer_store_dwordx4 v[88:91], v235, s[32:35], s51 offen sc1
    v_dot2_f32_bf16 v139, v49, v49, v139
    v_dot2_f32_bf16 v136, v50, v239, v136
    v_dot2_f32_bf16 v138, v50, v50, v138
    v_dot2_f32_bf16 v137, v51, v239, v137
    v_dot2_f32_bf16 v139, v51, v51, v139
    v_dot2_f32_bf16 v136, v52, v239, v136
    v_dot2_f32_bf16 v138, v52, v52, v138
    v_dot2_f32_bf16 v137, v53, v239, v137
    v_dot2_f32_bf16 v139, v53, v53, v139
    v_dot2_f32_bf16 v136, v54, v239, v136
    v_dot2_f32_bf16 v138, v54, v54, v138
    s_add_u32 s51, s98, 262272
    s_waitcnt lgkmcnt(2)
    buffer_store_dwordx4 v[92:95], v235, s[32:35], s51 offen sc1
    v_dot2_f32_bf16 v137, v55, v239, v137
    v_dot2_f32_bf16 v139, v55, v55, v139
    v_dot2_f32_bf16 v136, v56, v239, v136
    v_dot2_f32_bf16 v138, v56, v56, v138
    v_dot2_f32_bf16 v137, v57, v239, v137
    v_dot2_f32_bf16 v139, v57, v57, v139
    v_dot2_f32_bf16 v136, v58, v239, v136
    v_dot2_f32_bf16 v138, v58, v58, v138
    v_dot2_f32_bf16 v137, v59, v239, v137
    v_dot2_f32_bf16 v139, v59, v59, v139
    v_dot2_f32_bf16 v136, v60, v239, v136
    v_dot2_f32_bf16 v138, v60, v60, v138
    s_add_u32 s51, s98, 393344
    s_waitcnt lgkmcnt(1)
    buffer_store_dwordx4 v[96:99], v235, s[32:35], s51 offen sc1
    v_dot2_f32_bf16 v137, v61, v239, v137
    v_dot2_f32_bf16 v139, v61, v61, v139
    v_dot2_f32_bf16 v136, v62, v239, v136
    v_dot2_f32_bf16 v138, v62, v62, v138
    v_dot2_f32_bf16 v137, v63, v239, v137
    v_dot2_f32_bf16 v139, v63, v63, v139
    s_nop 1
    v_add_f32 v136, v136, v137
    v_add_f32 v138, v138, v139
    s_nop 0
    v_add_f32_dpp v136, v136, v136 row_ror:8 row_mask:0xf bank_mask:0xf
    v_add_f32_dpp v138, v138, v138 row_ror:8 row_mask:0xf bank_mask:0xf
    s_nop 0
    v_add_f32_dpp v136, v136, v136 row_ror:4 row_mask:0xf bank_mask:0xf
    s_add_u32 s51, s98, 524416
    s_waitcnt lgkmcnt(0)
    buffer_store_dwordx4 v[100:103], v235, s[32:35], s51 offen sc1
    v_add_f32_dpp v138, v138, v138 row_ror:4 row_mask:0xf bank_mask:0xf
    v_add_f32_dpp v136, v136, v136 row_ror:2 row_mask:0xf bank_mask:0xf
    s_nop 0
    v_add_f32_dpp v138, v138, v138 row_ror:2 row_mask:0xf bank_mask:0xf
    v_add_f32_dpp v136, v136, v136 row_ror:1 row_mask:0xf bank_mask:0xf
    s_nop 0
    v_add_f32_dpp v138, v138, v138 row_ror:1 row_mask:0xf bank_mask:0xf
    v_mul_f32 v136, 0x3acccccd, v136
    v_mul_f32 v138, 0x3acccccd, v138
    v_fma_f32 v138, -v136, v136, v138
    v_max_f32 v138, 0, v138
    v_add_f32 v138, 0x3727c5ac, v138
    v_rsq_f32 v138, v138
    s_mov_b32 s51, 262272
    v_mul_f32_e64 v139, -v136, v138
    buffer_store_dwordx2 v[138:139], v232, s[32:35], s51 offen sc1
    v_add_u32 v236, 114688, v234
    v_xor_b32 v237, 64, v236
    ds_read_b128 v[84:87], v236 offset:0
    ds_read_b128 v[88:91], v237 offset:1024
    ds_read_b128 v[92:95], v236 offset:2048
    ds_read_b128 v[96:99], v237 offset:3072
    ds_read_b128 v[100:103], v236 offset:4096
    s_add_u32 s51, s98, 256
    s_waitcnt lgkmcnt(4)
    buffer_store_dwordx4 v[84:87], v235, s[32:35], s51 offen sc1
    v_mov_b32 v239, 0x3f803f80
    v_dot2_f32_bf16 v136, v64, v239, 0
    v_dot2_f32_bf16 v138, v64, v64, 0
    v_dot2_f32_bf16 v137, v65, v239, 0
    v_dot2_f32_bf16 v139, v65, v65, 0
    v_dot2_f32_bf16 v136, v66, v239, v136
    v_dot2_f32_bf16 v138, v66, v66, v138
    v_dot2_f32_bf16 v137, v67, v239, v137
    v_dot2_f32_bf16 v139, v67, v67, v139
    v_dot2_f32_bf16 v136, v68, v239, v136
    v_dot2_f32_bf16 v138, v68, v68, v138
    v_dot2_f32_bf16 v137, v69, v239, v137
    s_add_u32 s51, s98, 131328
    s_waitcnt lgkmcnt(3)
    buffer_store_dwordx4 v[88:91], v235, s[32:35], s51 offen sc1
    v_dot2_f32_bf16 v139, v69, v69, v139
    v_dot2_f32_bf16 v136, v70, v239, v136
    v_dot2_f32_bf16 v138, v70, v70, v138
    v_dot2_f32_bf16 v137, v71, v239, v137
    v_dot2_f32_bf16 v139, v71, v71, v139
    v_dot2_f32_bf16 v136, v72, v239, v136
    v_dot2_f32_bf16 v138, v72, v72, v138
    v_dot2_f32_bf16 v137, v73, v239, v137
    v_dot2_f32_bf16 v139, v73, v73, v139
    v_dot2_f32_bf16 v136, v74, v239, v136
    v_dot2_f32_bf16 v138, v74, v74, v138
    s_add_u32 s51, s98, 262400
    s_waitcnt lgkmcnt(2)
    buffer_store_dwordx4 v[92:95], v235, s[32:35], s51 offen sc1
    v_dot2_f32_bf16 v137, v75, v239, v137
    v_dot2_f32_bf16 v139, v75, v75, v139
    v_dot2_f32_bf16 v136, v76, v239, v136
    v_dot2_f32_bf16 v138, v76, v76, v138
    v_dot2_f32_bf16 v137, v77, v239, v137
    v_dot2_f32_bf16 v139, v77, v77, v139
    v_dot2_f32_bf16 v136, v78, v239, v136
    v_dot2_f32_bf16 v138, v78, v78, v138
    v_dot2_f32_bf16 v137, v79, v239, v137
    v_dot2_f32_bf16 v139, v79, v79, v139
    v_dot2_f32_bf16 v136, v80, v239, v136
    v_dot2_f32_bf16 v138, v80, v80, v138
    s_add_u32 s51, s98, 393472
    s_waitcnt lgkmcnt(1)
    buffer_store_dwordx4 v[96:99], v235, s[32:35], s51 offen sc1
    v_dot2_f32_bf16 v137, v81, v239, v137
    v_dot2_f32_bf16 v139, v81, v81, v139
    v_dot2_f32_bf16 v136, v82, v239, v136
    v_dot2_f32_bf16 v138, v82, v82, v138
    v_dot2_f32_bf16 v137, v83, v239, v137
    v_dot2_f32_bf16 v139, v83, v83, v139
    s_nop 1
    v_add_f32 v136, v136, v137
    v_add_f32 v138, v138, v139
    s_nop 0
    v_add_f32_dpp v136, v136, v136 row_ror:8 row_mask:0xf bank_mask:0xf
    v_add_f32_dpp v138, v138, v138 row_ror:8 row_mask:0xf bank_mask:0xf
    s_nop 0
    v_add_f32_dpp v136, v136, v136 row_ror:4 row_mask:0xf bank_mask:0xf
    s_add_u32 s51, s98, 524544
    s_waitcnt lgkmcnt(0)
    buffer_store_dwordx4 v[100:103], v235, s[32:35], s51 offen sc1
    v_add_f32_dpp v138, v138, v138 row_ror:4 row_mask:0xf bank_mask:0xf
    v_add_f32_dpp v136, v136, v136 row_ror:2 row_mask:0xf bank_mask:0xf
    s_nop 0
    v_add_f32_dpp v138, v138, v138 row_ror:2 row_mask:0xf bank_mask:0xf
    v_add_f32_dpp v136, v136, v136 row_ror:1 row_mask:0xf bank_mask:0xf
    s_nop 0
    v_add_f32_dpp v138, v138, v138 row_ror:1 row_mask:0xf bank_mask:0xf
    v_mul_f32 v136, 0x3acccccd, v136
    v_mul_f32 v138, 0x3acccccd, v138
    v_fma_f32 v138, -v136, v136, v138
    v_max_f32 v138, 0, v138
    v_add_f32 v138, 0x3727c5ac, v138
    v_rsq_f32 v138, v138
    s_mov_b32 s51, 262400
    v_mul_f32_e64 v139, -v136, v138
    buffer_store_dwordx2 v[138:139], v232, s[32:35], s51 offen sc1
    s_mov_b32 s53, 160
LWj:
    s_add_u32 s53, s53, s45
    s_lshl_b32 s51, s44, 10
    s_add_u32 m0, s51, 49152
    s_nop 0
    global_load_lds_dwordx4 v216, s[22:23] nt
    s_add_u32 m0, s51, 53248
    s_nop 0
    global_load_lds_dwordx4 v217, s[22:23] nt
    s_add_u32 m0, s51, 57344
    s_nop 0
    global_load_lds_dwordx4 v218, s[22:23] nt
    s_add_u32 m0, s51, 61440
    s_nop 0
    global_load_lds_dwordx4 v219, s[22:23] nt
    s_add_u32 m0, s51, 65536
    s_nop 0
    global_load_lds_dwordx4 v220, s[22:23] nt
    s_and_b32 s47, s49, 1
    s_lshl_b32 s47, s47, 3
    s_lshr_b32 s57, s50, 2
    s_add_u32 s47, s47, s57
    s_lshr_b32 s48, s49, 1
    s_lshl_b32 s48, s48, 2
    s_and_b32 s58, s50, 3
    s_add_u32 s48, s48, s58
    s_lshl_b32 s3, s47, 4
    s_add_u32 s3, s3, s48
    s_lshr_b32 s69, s48, 3
    s_lshl_b32 s69, s69, 2
    s_add_u32 s69, s69, s58
    s_lshl_b32 s58, s48, 2
    s_add_u32 s58, s58, s44
    s_mul_i32 s60, s58, 61440
    s_add_u32 s60, s60, 8912896
    s_mul_i32 s65, s69, 245760
    s_mul_i32 s51, s44, 61440
    s_add_u32 s65, s65, s51
    s_add_u32 s65, s65, 13107200
    s_mul_i32 s64, s47, 196608
    s_add_u32 s64, s64, 15204352
    s_bfe_u32 s57, s48, 0x10002
    s_mul_i32 s57, s57, 49152
    s_add_u32 s57, s57, s64
    s_mul_i32 s51, s44, 12288
    s_add_u32 s57, s57, s51
    s_lshr_b32 s51, s44, 1
    s_mul_i32 s51, s51, 98304
    s_add_u32 s67, s57, s51
    s_sub_u32 s57, s57, s51
    s_add_u32 s71, s57, 98304
    s_lshl_b32 s0, s44, 11
    s_lshl_b32 s51, s44, 17
    s_lshl_b32 s56, s47, 9
    s_add_u32 s51, s51, s56
    s_add_u32 s62, s51, 6291456
    s_lshl_b32 s70, s47, 11
    s_add_u32 s70, s70, 21495808
    v_and_b32 v244, 15, v1
    v_lshrrev_b32 v245, 4, v1
    v_add_u32 v5, 3072, v4
    v_add_u32 v6, 4096, v4
    s_lshr_b32 s51, s48, 2
    v_min_u32 v246, 19, v1
    v_lshl_add_u32 v246, v246, 2, s51
    v_lshlrev_b32 v15, 7, v246
    s_mul_i32 s51, s44, 24
    v_min_u32 v248, 23, v1
    v_add_u32 v248, s51, v248
    v_lshlrev_b32 v16, 7, v248
    v_bfe_u32 v17, v1, 2, 2
    v_mul_u32_u24 v17, 12288, v17
    v_lshl_add_u32 v17, v245, 4, v17
    s_mul_i32 s51, s58, 192
    v_add_u32 v17, s51, v17
    s_lshl_b32 s51, s47, 4
    s_lshl_b32 s56, s44, 2
    s_add_u32 s51, s51, s56
    v_add_u32 v18, s51, v245
    v_lshlrev_b32 v18, 7, v18
    v_min_u32 v14, 39, v1
    s_mul_i32 s51, s44, 40
    v_add_u32 v14, s51, v14
    v_lshlrev_b32 v14, 7, v14
    v_and_b32 v247, 1, v245
    v_and_b32 v248, 2, v245
    v_lshlrev_b32 v248, 5, v248
    v_lshl_add_u32 v248, v247, 7, v248
    v_lshlrev_b32 v246, 3, v244
    v_xor_b32 v246, v246, v248
    v_lshl_add_u32 v246, v245, 8, v246
    v_add_u32 v8, 122880, v246
    v_xor_b32 v9, 128, v8
    v_xor_b32 v22, 32, v8
    v_xor_b32 v23, 32, v9
    v_lshlrev_b32 v246, 4, v244
    v_xor_b32 v246, v246, v248
    s_and_b32 s51, s44, 1
    s_lshl_b32 s51, s51, 5
    v_xor_b32 v246, s51, v246
    v_lshl_add_u32 v10, v245, 14, v246
    v_add_u32 v11, 64512, v10
    v_lshrrev_b32 v246, 5, v1
    v_mul_u32_u24 v246, 49152, v246
    v_lshl_add_u32 v246, v244, 4, v246
    s_mul_i32 s51, s58, 768
    v_add_u32 v246, s51, v246
    v_cmp_eq_u32 vcc, 0, v247
    v_lshl_add_u32 v12, v247, 8, v246
    v_mov_b32 v248, 0x80000000
    v_cndmask_b32 v13, v248, v246, vcc
    s_and_b32 s51, s58, 31
    s_lshl_b32 s51, s51, 3
    v_and_b32 v246, 1, v1
    v_lshlrev_b32 v246, 7, v246
    v_and_b32 v247, 2, v1
    v_lshl_add_u32 v246, v247, 5, v246
    v_and_b32 v247, 8, v1
    v_lshl_add_u32 v246, v247, 2, v246
    v_xor_b32 v246, s51, v246
    v_lshl_add_u32 v19, v1, 8, v246
    s_cmp_lt_u32 s58, 32
    s_cselect_b32 s51, 0, 32
    s_cselect_b32 s56, 32, 0
    v_add_u32 v19, 122880, v19
    s_lshl_b32 s57, s51, 3
    s_add_u32 s90, s62, s57
    s_lshl_b32 s57, s56, 3
    s_add_u32 s91, s62, s57
    v_and_b32 v246, 60, v1
    v_add_u32 v246, v246, v1
    v_lshlrev_b32 v246, 4, v246
    s_lshl_b32 s92, s51, 5
    v_xor_b32 v21, s92, v246
    s_mul_i32 s57, s51, 3072
    s_add_u32 s94, s64, s57
    s_mul_i32 s57, s56, 3072
    s_add_u32 s95, s64, s57
    s_mul_i32 s96, s44, 10240
    s_lshl_b32 s51, s48, 7
    s_lshl_b32 s56, s44, 4
    s_add_u32 s51, s51, s56
    s_sub_u32 s51, s51, 3968
    v_lshl_add_u32 v246, v1, 6, s51
    v_mov_b32 v248, 0x80000000
    v_cmp_le_u32 vcc, 62, v1
    s_nop 1
    v_cndmask_b32 v20, v248, v246, vcc
    s_waitcnt vmcnt(5)
    s_barrier
    s_lshl_b32 s51, s53, 7
    s_add_u32 s51, s51, 22020096
    buffer_store_dword v2, v3, s[32:35], s51 offen sc1
    s_mov_b32 s99, 1
    s_mov_b64 exec, 0
    s_cmp_eq_u32 s44, 0
    s_cbranch_scc1 LhopW0
    s_cmp_eq_u32 s44, 1
    s_cbranch_scc1 LhopW1
    s_cmp_eq_u32 s44, 2
    s_cbranch_scc1 LhopW2
    s_branch LhopW3
LretW:
    s_waitcnt vmcnt(1)
    s_barrier
    s_mov_b32 s58, 22061056
    buffer_load_dword v140, v15, s[32:35], s58 offen sc1
    v_bfe_u32 v236, v1, 2, 2
    v_bfe_u32 v239, v1, 4, 1
    v_lshl_add_u32 v236, v239, 3, v236
    v_mul_u32_u24 v236, 1280, v236
    v_lshrrev_b32 v240, 5, v1
    s_lshl_b32 s51, s44, 1
    v_add_u32 v240, s51, v240
    v_mul_u32_u24 v241, 160, v240
    v_add_u32 v236, v236, v241
    v_and_b32 v241, 3, v1
    v_lshl_add_u32 v236, v241, 3, v236
    v_add_u32 v236, 49152, v236
    v_mul_u32_u24 v240, 245760, v240
    v_and_b32 v241, 31, v1
    v_lshl_add_u32 v240, v241, 4, v240
    s_lshr_b32 s51, s45, 1
    s_mul_i32 s51, s51, 5120
    s_and_b32 s56, s45, 1
    s_lshl_b32 s56, s56, 9
    s_add_u32 s51, s51, s56
    s_add_u32 s51, s51, 13107200
    ds_read_b64_tr_b16 v[84:85], v236 offset:0
    ds_read_b64_tr_b16 v[86:87], v236 offset:5120
    ds_read_b64_tr_b16 v[88:89], v236 offset:32
    ds_read_b64_tr_b16 v[90:91], v236 offset:5152
    ds_read_b64_tr_b16 v[92:93], v236 offset:64
    ds_read_b64_tr_b16 v[94:95], v236 offset:5184
    ds_read_b64_tr_b16 v[96:97], v236 offset:96
    ds_read_b64_tr_b16 v[98:99], v236 offset:5216
    ds_read_b64_tr_b16 v[100:101], v236 offset:128
    ds_read_b64_tr_b16 v[102:103], v236 offset:5248
    s_waitcnt lgkmcnt(8)
    buffer_store_dwordx4 v[84:87], v240, s[32:35], s51 offen sc1
    s_add_u32 s51, s51, 1024
    s_waitcnt lgkmcnt(6)
    buffer_store_dwordx4 v[88:91], v240, s[32:35], s51 offen sc1
    s_add_u32 s51, s51, 1024
    s_waitcnt lgkmcnt(4)
    buffer_store_dwordx4 v[92:95], v240, s[32:35], s51 offen sc1
    s_add_u32 s51, s51, 1024
    s_waitcnt lgkmcnt(2)
    buffer_store_dwordx4 v[96:99], v240, s[32:35], s51 offen sc1
    s_add_u32 s51, s51, 1024
    s_waitcnt lgkmcnt(0)
    buffer_store_dwordx4 v[100:103], v240, s[32:35], s51 offen sc1
    v_min_u32 v243, 79, v0
    v_lshrrev_b32 v242, 1, v243
    v_and_b32 v243, 1, v243
    s_mul_i32 s51, s55, 5120
    v_lshlrev_b32 v230, 7, v242
    v_lshl_add_u32 v230, v243, 4, v230
    v_add_u32 v230, s51, v230
    v_lshlrev_b32 v242, 3, v242
    v_lshl_add_u32 v242, v243, 9, v242
    v_add_u32 v242, 69632, v242
    v_lshrrev_b32 v237, 4, v1
    v_and_b32 v236, 1, v1
    v_lshlrev_b32 v238, 3, v237
    v_lshl_add_u32 v238, v236, 9, v238
    v_add_u32 v238, 69632, v238
    v_lshlrev_b32 v239, 4, v237
    v_lshl_add_u32 v239, v236, 16, v239
    v_and_b32 v236, 14, v1
    s_cmp_lt_u32 s54, 4
    s_cselect_b32 s51, 0, 1
    s_cselect_b32 s53, 0, 96
    v_cmp_eq_u32 vcc, s51, v236
    v_mov_b32 v240, 0x80000000
    s_nop 0
    v_cndmask_b32 v239, v240, v239, vcc
    s_lshl_b32 s51, s48, 2
    s_add_u32 s53, s53, s51
    s_add_u32 s53, s53, s55
    s_add_u32 s51, s51, s44
    s_mul_i32 s51, s51, 192
    s_mul_i32 s56, s55, 12288
    s_add_u32 s51, s51, s56
    s_add_u32 s56, s51, 294912
    s_mov_b32 s57, 434176
    s_waitcnt vmcnt(5)
    v_cmp_ne_u32 vcc, v2, v140
    s_nop 1
    s_cbranch_vccnz Lspin16
Lback16:
    s_add_u32 s61, s60, 0
    buffer_load_dwordx4 a[128:131], v4, s[32:35], s61 offen offset:0 sc1
    buffer_load_dwordx4 a[132:135], v4, s[32:35], s61 offen offset:1024 sc1
    buffer_load_dwordx4 a[136:139], v4, s[32:35], s61 offen offset:2048 sc1
    buffer_load_dwordx4 a[140:143], v5, s[32:35], s61 offen offset:0 sc1
    buffer_load_dwordx4 a[144:147], v5, s[32:35], s61 offen offset:1024 sc1
    buffer_load_dwordx4 a[148:151], v5, s[32:35], s61 offen offset:2048 sc1
    s_add_u32 s61, s60, 6144
    buffer_load_dwordx4 a[152:155], v4, s[32:35], s61 offen offset:0 sc1
    buffer_load_dwordx4 a[156:159], v4, s[32:35], s61 offen offset:1024 sc1
    buffer_load_dwordx4 a[160:163], v4, s[32:35], s61 offen offset:2048 sc1
    buffer_load_dwordx4 a[164:167], v5, s[32:35], s61 offen offset:0 sc1
    buffer_load_dwordx4 a[168:171], v5, s[32:35], s61 offen offset:1024 sc1
    buffer_load_dwordx4 a[172:175], v5, s[32:35], s61 offen offset:2048 sc1
    s_waitcnt vmcnt(12)
    s_barrier
    s_lshl_b32 s51, s45, 7
    s_add_u32 s51, s51, 22073344
    buffer_store_dword v2, v3, s[32:35], s51 offen sc1
    s_add_u32 s61, s60, 12288
    buffer_load_dwordx4 a[176:179], v4, s[32:35], s61 offen offset:0 sc1
    buffer_load_dwordx4 a[180:183], v4, s[32:35], s61 offen offset:1024 sc1
    buffer_load_dwordx4 a[184:187], v4, s[32:35], s61 offen offset:2048 sc1
    buffer_load_dwordx4 a[188:191], v5, s[32:35], s61 offen offset:0 sc1
    buffer_load_dwordx4 a[192:195], v5, s[32:35], s61 offen offset:1024 sc1
    buffer_load_dwordx4 a[196:199], v5, s[32:35], s61 offen offset:2048 sc1
    s_add_u32 s61, s60, 18432
    buffer_load_dwordx4 a[200:203], v4, s[32:35], s61 offen offset:0 sc1
    buffer_load_dwordx4 a[204:207], v4, s[32:35], s61 offen offset:1024 sc1
    buffer_load_dwordx4 a[208:211], v4, s[32:35], s61 offen offset:2048 sc1
    buffer_load_dwordx4 a[212:215], v5, s[32:35], s61 offen offset:0 sc1
    buffer_load_dwordx4 a[216:219], v5, s[32:35], s61 offen offset:1024 sc1
    buffer_load_dwordx4 a[220:223], v5, s[32:35], s61 offen offset:2048 sc1
    s_add_u32 s61, s60, 24576
    buffer_load_dwordx4 a[224:227], v4, s[32:35], s61 offen offset:0 sc1
    buffer_load_dwordx4 a[228:231], v4, s[32:35], s61 offen offset:1024 sc1
    buffer_load_dwordx4 a[232:235], v4, s[32:35], s61 offen offset:2048 sc1
    buffer_load_dwordx4 a[236:239], v5, s[32:35], s61 offen offset:0 sc1
    buffer_load_dwordx4 a[0:3], v5, s[32:35], s61 offen offset:1024 sc1
    buffer_load_dwordx4 a[4:7], v5, s[32:35], s61 offen offset:2048 sc1
    s_add_u32 s61, s60, 30720
    buffer_load_dwordx4 a[8:11], v4, s[32:35], s61 offen offset:0 sc1
    buffer_load_dwordx4 a[12:15], v4, s[32:35], s61 offen offset:1024 sc1
    buffer_load_dwordx4 a[16:19], v4, s[32:35], s61 offen offset:2048 sc1
    buffer_load_dwordx4 a[20:23], v5, s[32:35], s61 offen offset:0 sc1
    buffer_load_dwordx4 a[24:27], v5, s[32:35], s61 offen offset:1024 sc1
    buffer_load_dwordx4 a[28:31], v5, s[32:35], s61 offen offset:2048 sc1
    s_add_u32 s61, s60, 36864
    buffer_load_dwordx4 a[32:35], v4, s[32:35], s61 offen offset:0 sc1
    buffer_load_dwordx4 a[36:39], v4, s[32:35], s61 offen offset:1024 sc1
    buffer_load_dwordx4 a[40:43], v4, s[32:35], s61 offen offset:2048 sc1
    buffer_load_dwordx4 a[44:47], v5, s[32:35], s61 offen offset:0 sc1
    buffer_load_dwordx4 v[104:107], v230, s[32:35], s57 offen sc1
    s_add_u32 s61, s60, 36864
    buffer_load_dwordx4 a[48:51], v5, s[32:35], s61 offen offset:1024 sc1
    buffer_load_dwordx4 a[52:55], v5, s[32:35], s61 offen offset:2048 sc1
    s_add_u32 s61, s60, 43008
    buffer_load_dwordx4 a[56:59], v4, s[32:35], s61 offen offset:0 sc1
    buffer_load_dwordx4 a[60:63], v4, s[32:35], s61 offen offset:1024 sc1
    buffer_load_dwordx4 a[64:67], v4, s[32:35], s61 offen offset:2048 sc1
    buffer_load_dwordx4 a[68:71], v5, s[32:35], s61 offen offset:0 sc1
    buffer_load_dwordx4 a[72:75], v5, s[32:35], s61 offen offset:1024 sc1
    buffer_load_dwordx4 a[76:79], v5, s[32:35], s61 offen offset:2048 sc1
    s_add_u32 s61, s60, 49152
    buffer_load_dwordx4 a[80:83], v4, s[32:35], s61 offen offset:0 sc1
    buffer_load_dwordx4 a[84:87], v4, s[32:35], s61 offen offset:1024 sc1
    s_waitcnt vmcnt(10)
    v_cmp_ne_u32 vcc, v2, v105
    v_cmp_ne_u32 s[16:17], v2, v107
    s_nop 1
    s_or_b64 vcc, vcc, s[16:17]
    s_cbranch_vccnz Lspin17
Lback17:
    ds_write2_b32 v242, v104, v106 offset1:1
    s_add_u32 s61, s60, 49152
    buffer_load_dwordx4 a[88:91], v4, s[32:35], s61 offen offset:2048 sc1
    buffer_load_dwordx4 a[92:95], v5, s[32:35], s61 offen offset:0 sc1
    buffer_load_dwordx4 a[96:99], v5, s[32:35], s61 offen offset:1024 sc1
    buffer_load_dwordx4 a[100:103], v5, s[32:35], s61 offen offset:2048 sc1
    s_add_u32 s61, s60, 55296
    buffer_load_dwordx4 a[104:107], v4, s[32:35], s61 offen offset:0 sc1
    buffer_load_dwordx4 a[108:111], v4, s[32:35], s61 offen offset:1024 sc1
    buffer_load_dwordx4 a[112:115], v4, s[32:35], s61 offen offset:2048 sc1
    buffer_load_dwordx4 a[116:119], v5, s[32:35], s61 offen offset:0 sc1
    buffer_load_dwordx4 a[120:123], v5, s[32:35], s61 offen offset:1024 sc1
    buffer_load_dwordx4 a[124:127], v5, s[32:35], s61 offen offset:2048 sc1
    s_mov_b32 s1, 22085632
    buffer_load_dword v90, v14, s[32:35], s1 offen sc1
    s_waitcnt lgkmcnt(0)
    s_barrier
    ds_read_b64 v[116:117], v238 offset:0
    ds_read_b64 v[118:119], v238 offset:32
    ds_read_b64 v[120:121], v238 offset:64
    ds_read_b64 v[122:123], v238 offset:96
    ds_read_b64 v[124:125], v238 offset:128
    ds_read_b64 v[126:127], v238 offset:160
    ds_read_b64 v[128:129], v238 offset:192
    ds_read_b64 v[130:131], v238 offset:224
    ds_read_b64 v[132:133], v238 offset:256
    ds_read_b64 v[134:135], v238 offset:288
    s_waitcnt vmcnt(1)
    s_waitcnt lgkmcnt(0)
    s_cmp_lg_u32 s55, 0
    s_cbranch_scc1 LWc1
    v_mfma_f32_16x16x32_bf16 v[104:107], a[128:131], v[116:119], 0
    v_mfma_f32_16x16x32_bf16 v[104:107], a[140:143], v[120:123], v[104:107]
    v_mfma_f32_16x16x32_bf16 v[104:107], a[152:155], v[124:127], v[104:107]
    v_mfma_f32_16x16x32_bf16 v[104:107], a[164:167], v[128:131], v[104:107]
    v_mfma_f32_16x16x32_bf16 v[104:107], a[176:179], v[132:135], v[104:107]
    v_mfma_f32_16x16x32_bf16 v[108:111], a[132:135], v[116:119], 0
    v_mfma_f32_16x16x32_bf16 v[108:111], a[144:147], v[120:123], v[108:111]
    v_mfma_f32_16x16x32_bf16 v[108:111], a[156:159], v[124:127], v[108:111]
    v_mfma_f32_16x16x32_bf16 v[108:111], a[168:171], v[128:131], v[108:111]
    v_mfma_f32_16x16x32_bf16 v[108:111], a[180:183], v[132:135], v[108:111]
    v_mfma_f32_16x16x32_bf16 v[112:115], a[136:139], v[116:119], 0
    v_mfma_f32_16x16x32_bf16 v[112:115], a[148:151], v[120:123], v[112:115]
    v_mfma_f32_16x16x32_bf16 v[112:115], a[160:163], v[124:127], v[112:115]
    v_mfma_f32_16x16x32_bf16 v[112:115], a[172:175], v[128:131], v[112:115]
    v_mfma_f32_16x16x32_bf16 v[112:115], a[184:187], v[132:135], v[112:115]
    s_branch LWc4
LWc1:
    s_cmp_lg_u32 s55, 1
    s_cbranch_scc1 LWc2
    v_mfma_f32_16x16x32_bf16 v[104:107], a[188:191], v[116:119], 0
    v_mfma_f32_16x16x32_bf16 v[104:107], a[200:203], v[120:123], v[104:107]
    v_mfma_f32_16x16x32_bf16 v[104:107], a[212:215], v[124:127], v[104:107]
    v_mfma_f32_16x16x32_bf16 v[104:107], a[224:227], v[128:131], v[104:107]
    v_mfma_f32_16x16x32_bf16 v[104:107], a[236:239], v[132:135], v[104:107]
    v_mfma_f32_16x16x32_bf16 v[108:111], a[192:195], v[116:119], 0
    v_mfma_f32_16x16x32_bf16 v[108:111], a[204:207], v[120:123], v[108:111]
    v_mfma_f32_16x16x32_bf16 v[108:111], a[216:219], v[124:127], v[108:111]
    v_mfma_f32_16x16x32_bf16 v[108:111], a[228:231], v[128:131], v[108:111]
    v_mfma_f32_16x16x32_bf16 v[108:111], a[0:3], v[132:135], v[108:111]
    v_mfma_f32_16x16x32_bf16 v[112:115], a[196:199], v[116:119], 0
    v_mfma_f32_16x16x32_bf16 v[112:115], a[208:211], v[120:123], v[112:115]
    v_mfma_f32_16x16x32_bf16 v[112:115], a[220:223], v[124:127], v[112:115]
    v_mfma_f32_16x16x32_bf16 v[112:115], a[232:235], v[128:131], v[112:115]
    v_mfma_f32_16x16x32_bf16 v[112:115], a[4:7], v[132:135], v[112:115]
    s_branch LWc4
LWc2:
    s_cmp_lg_u32 s55, 2
    s_cbranch_scc1 LWc3
    v_mfma_f32_16x16x32_bf16 v[104:107], a[8:11], v[116:119], 0
    v_mfma_f32_16x16x32_bf16 v[104:107], a[20:23], v[120:123], v[104:107]
    v_mfma_f32_16x16x32_bf16 v[104:107], a[32:35], v[124:127], v[104:107]
    v_mfma_f32_16x16x32_bf16 v[104:107], a[44:47], v[128:131], v[104:107]
    v_mfma_f32_16x16x32_bf16 v[104:107], a[56:59], v[132:135], v[104:107]
    v_mfma_f32_16x16x32_bf16 v[108:111], a[12:15], v[116:119], 0
    v_mfma_f32_16x16x32_bf16 v[108:111], a[24:27], v[120:123], v[108:111]
    v_mfma_f32_16x16x32_bf16 v[108:111], a[36:39], v[124:127], v[108:111]
    v_mfma_f32_16x16x32_bf16 v[108:111], a[48:51], v[128:131], v[108:111]
    v_mfma_f32_16x16x32_bf16 v[108:111], a[60:63], v[132:135], v[108:111]
    v_mfma_f32_16x16x32_bf16 v[112:115], a[16:19], v[116:119], 0
    v_mfma_f32_16x16x32_bf16 v[112:115], a[28:31], v[120:123], v[112:115]
    v_mfma_f32_16x16x32_bf16 v[112:115], a[40:43], v[124:127], v[112:115]
    v_mfma_f32_16x16x32_bf16 v[112:115], a[52:55], v[128:131], v[112:115]
    v_mfma_f32_16x16x32_bf16 v[112:115], a[64:67], v[132:135], v[112:115]
    s_branch LWc4
LWc3:
    v_mfma_f32_16x16x32_bf16 v[104:107], a[68:71], v[116:119], 0
    v_mfma_f32_16x16x32_bf16 v[104:107], a[80:83], v[120:123], v[104:107]
    v_mfma_f32_16x16x32_bf16 v[104:107], a[92:95], v[124:127], v[104:107]
    v_mfma_f32_16x16x32_bf16 v[104:107], a[104:107], v[128:131], v[104:107]
    v_mfma_f32_16x16x32_bf16 v[104:107], a[116:119], v[132:135], v[104:107]
    v_mfma_f32_16x16x32_bf16 v[108:111], a[72:75], v[116:119], 0
    v_mfma_f32_16x16x32_bf16 v[108:111], a[84:87], v[120:123], v[108:111]
    v_mfma_f32_16x16x32_bf16 v[108:111], a[96:99], v[124:127], v[108:111]
    v_mfma_f32_16x16x32_bf16 v[108:111], a[108:111], v[128:131], v[108:111]
    v_mfma_f32_16x16x32_bf16 v[108:111], a[120:123], v[132:135], v[108:111]
    v_mfma_f32_16x16x32_bf16 v[112:115], a[76:79], v[116:119], 0
    v_mfma_f32_16x16x32_bf16 v[112:115], a[88:91], v[120:123], v[112:115]
    v_mfma_f32_16x16x32_bf16 v[112:115], a[100:103], v[124:127], v[112:115]
    v_mfma_f32_16x16x32_bf16 v[112:115], a[112:115], v[128:131], v[112:115]
    v_mfma_f32_16x16x32_bf16 v[112:115], a[124:127], v[132:135], v[112:115]
LWc4:
    s_nop 7
    buffer_store_dwordx4 v[104:107], v239, s[32:35], s56 offen offset:0 sc1
    buffer_store_dwordx4 v[108:111], v239, s[32:35], s56 offen offset:64 sc1
    buffer_store_dwordx4 v[112:115], v239, s[32:35], s56 offen offset:128 sc1
    s_waitcnt vmcnt(3)
    v_cmp_ne_u32 vcc, v2, v90
    s_nop 1
    s_cbranch_vccnz Lspin18
Lback18:
    s_barrier
    s_add_u32 m0, s0, 122880
    s_add_u32 s63, s90, 0
    buffer_load_dwordx4 v10, s[32:35], s63 offen sc1 lds
    buffer_load_dwordx4 v11, s[32:35], s63 offen offset:1024 sc1 lds
    s_add_u32 m0, s0, 131072
    s_add_u32 s63, s90, 524288
    buffer_load_dwordx4 v10, s[32:35], s63 offen sc1 lds
    buffer_load_dwordx4 v11, s[32:35], s63 offen offset:1024 sc1 lds
    s_add_u32 m0, s0, 139264
    s_add_u32 s63, s90, 1048576
    buffer_load_dwordx4 v10, s[32:35], s63 offen sc1 lds
    buffer_load_dwordx4 v11, s[32:35], s63 offen offset:1024 sc1 lds
    s_waitcnt vmcnt(6)
    s_barrier
    s_lshl_b32 s51, s53, 7
    s_add_u32 s51, s51, 22237184
    buffer_store_dword v2, v3, s[32:35], s51 offen sc1
    s_add_u32 m0, s0, 147456
    s_add_u32 s63, s90, 1572864
    buffer_load_dwordx4 v10, s[32:35], s63 offen sc1 lds
    buffer_load_dwordx4 v11, s[32:35], s63 offen offset:1024 sc1 lds
    s_add_u32 m0, s0, 155648
    s_add_u32 s63, s90, 2097152
    buffer_load_dwordx4 v10, s[32:35], s63 offen sc1 lds
    buffer_load_dwordx4 v11, s[32:35], s63 offen offset:1024 sc1 lds
    v_lshrrev_b32 v170, 5, v1
    v_lshl_add_u32 v170, v170, 31, v4
    s_mov_b32 s54, 425984
    buffer_load_dwordx4 v[152:155], v4, s[32:35], s54 offen sc1
    buffer_load_dwordx4 v[156:159], v4, s[32:35], s54 offen offset:1024 sc1
    buffer_load_dwordx4 v[160:163], v170, s[32:35], s54 offen offset:2048 sc1
    s_waitcnt vmcnt(0)
    s_waitcnt lgkmcnt(0)
    s_nop 4
    s_branch LG
Lspin1:
    s_mov_b32 s59, 0
Lspin1_l:
    buffer_load_dword v36, v33, s[32:35], s57 offen sc1
    s_waitcnt vmcnt(0)
    v_cmp_ne_u32 vcc, v2, v36
    s_nop 1
    s_cbranch_vccz Lback1
    s_add_u32 s59, s59, 1
    s_cmp_lt_u32 s59, 200000
    s_cbranch_scc1 Lspin1_l
    s_branch Lback1
Lspin2:
    s_mov_b32 s59, 0
Lspin2_l:
    buffer_load_dword v37, v34, s[32:35], s1 offen sc1
    s_waitcnt vmcnt(0)
    v_cmp_ne_u32 vcc, v2, v37
    s_nop 1
    s_cbranch_vccz Lback2
    s_add_u32 s59, s59, 1
    s_cmp_lt_u32 s59, 200000
    s_cbranch_scc1 Lspin2_l
    s_branch Lback2
Lspin3:
    s_mov_b32 s59, 0
Lspin3_l:
    buffer_load_dwordx4 v[40:43], v35, s[32:35], s58 offen sc1
    s_waitcnt vmcnt(0)
    v_cmp_ne_u32 vcc, v2, v41
    v_cmp_ne_u32 s[16:17], v2, v43
    s_nop 1
    s_or_b64 vcc, vcc, s[16:17]
    s_nop 1
    s_cbranch_vccz Lback3
    s_add_u32 s59, s59, 1
    s_cmp_lt_u32 s59, 200000
    s_cbranch_scc1 Lspin3_l
    s_branch Lback3
Lspin4:
    s_mov_b32 s59, 0
Lspin4_l:
    buffer_load_dword v38, v15, s[32:35], s97 offen sc1
    s_waitcnt vmcnt(0)
    v_cmp_ne_u32 vcc, v2, v38
    s_nop 1
    s_cbranch_vccz Lback4
    s_add_u32 s59, s59, 1
    s_cmp_lt_u32 s59, 200000
    s_cbranch_scc1 Lspin4_l
    s_branch Lback4
Lspin5:
    s_mov_b32 s59, 0
Lspin5_l:
    buffer_load_dword v37, v14, s[32:35], s1 offen sc1
    s_waitcnt vmcnt(0)
    v_cmp_ne_u32 vcc, v2, v37
    s_nop 1
    s_cbranch_vccz Lback5
    s_add_u32 s59, s59, 1
    s_cmp_lt_u32 s59, 200000
    s_cbranch_scc1 Lspin5_l
    s_branch Lback5
Lspin6:
    s_mov_b32 s59, 0
Lspin6_l:
    buffer_load_dword v36, v34, s[32:35], s57 offen sc1
    s_waitcnt vmcnt(0)
    v_cmp_ne_u32 vcc, v2, v36
    s_nop 1
    s_cbranch_vccz Lback6
    s_add_u32 s59, s59, 1
    s_cmp_lt_u32 s59, 200000
    s_cbranch_scc1 Lspin6_l
    s_branch Lback6
Lspin7:
    s_mov_b32 s59, 0
Lspin7_l:
    buffer_load_dword v181, v16, s[32:35], s4 offen sc1
    s_waitcnt vmcnt(0)
    v_cmp_ne_u32 vcc, v2, v181
    s_nop 1
    s_cbranch_vccz Lback7
    s_add_u32 s59, s59, 1
    s_cmp_lt_u32 s59, 200000
    s_cbranch_scc1 Lspin7_l
    s_branch Lback7
Lspin8:
    s_mov_b32 s59, 0
Lspin8_l:
    buffer_load_dword v180, v14, s[32:35], s1 offen sc1
    s_waitcnt vmcnt(0)
    v_cmp_ne_u32 vcc, v2, v180
    s_nop 1
    s_cbranch_vccz Lback8
    s_add_u32 s59, s59, 1
    s_cmp_lt_u32 s59, 200000
    s_cbranch_scc1 Lspin8_l
    s_branch Lback8
Lspin9:
    s_mov_b32 s59, 0
Lspin9_l:
    buffer_load_dwordx4 v[176:179], v21, s[32:35], s8 offen sc1
    s_waitcnt vmcnt(0)
    v_cmp_ne_u32 vcc, v2, v177
    v_cmp_ne_u32 s[16:17], v2, v179
    s_nop 1
    s_or_b64 vcc, vcc, s[16:17]
    s_nop 1
    s_cbranch_vccz Lback9
    s_add_u32 s59, s59, 1
    s_cmp_lt_u32 s59, 200000
    s_cbranch_scc1 Lspin9_l
    s_branch Lback9
Lspin10:
    s_mov_b32 s59, 0
Lspin10_l:
    buffer_load_dwordx4 v[176:179], v21, s[32:35], s8 offen sc1
    s_waitcnt vmcnt(0)
    v_cmp_ne_u32 vcc, v2, v177
    v_cmp_ne_u32 s[16:17], v2, v179
    s_nop 1
    s_or_b64 vcc, vcc, s[16:17]
    s_nop 1
    s_cbranch_vccz Lback10
    s_add_u32 s59, s59, 1
    s_cmp_lt_u32 s59, 200000
    s_cbranch_scc1 Lspin10_l
    s_branch Lback10
Lspin11:
    s_mov_b32 s59, 0
Lspin11_l:
    buffer_load_dword v181, v18, s[32:35], s1 offen sc1
    s_waitcnt vmcnt(0)
    v_cmp_ne_u32 vcc, v2, v181
    s_nop 1
    s_cbranch_vccz Lback11
    s_add_u32 s59, s59, 1
    s_cmp_lt_u32 s59, 200000
    s_cbranch_scc1 Lspin11_l
    s_branch Lback11
Lspin12:
    s_mov_b32 s59, 0
Lspin12_l:
    buffer_load_dword v182, v18, s[32:35], s4 offen sc1
    s_waitcnt vmcnt(0)
    v_cmp_ne_u32 vcc, v2, v182
    s_nop 1
    s_cbranch_vccz Lback12
    s_add_u32 s59, s59, 1
    s_cmp_lt_u32 s59, 200000
    s_cbranch_scc1 Lspin12_l
    s_branch Lback12
Lspin13:
    s_mov_b32 s59, 0
Lspin13_l:
    buffer_load_dword v182, v15, s[32:35], s9 offen sc1
    s_waitcnt vmcnt(0)
    v_cmp_ne_u32 vcc, v2, v182
    s_nop 1
    s_cbranch_vccz Lback13
    s_add_u32 s59, s59, 1
    s_cmp_lt_u32 s59, 200000
    s_cbranch_scc1 Lspin13_l
    s_branch Lback13
Lspin14:
    s_mov_b32 s59, 0
Lspin14_l:
    buffer_load_dword v181, v18, s[32:35], s1 offen sc1
    s_waitcnt vmcnt(0)
    v_cmp_ne_u32 vcc, v2, v181
    s_nop 1
    s_cbranch_vccz Lback14
    s_add_u32 s59, s59, 1
    s_cmp_lt_u32 s59, 200000
    s_cbranch_scc1 Lspin14_l
    s_branch Lback14
Lspin15:
    s_mov_b32 s59, 0
Lspin15_l:
    buffer_load_dword v180, v18, s[32:35], s8 offen sc1
    s_waitcnt vmcnt(0)
    v_cmp_ne_u32 vcc, v2, v180
    s_nop 1
    s_cbranch_vccz Lback15
    s_add_u32 s59, s59, 1
    s_cmp_lt_u32 s59, 200000
    s_cbranch_scc1 Lspin15_l
    s_branch Lback15
Lspin16:
    s_mov_b32 s59, 0
Lspin16_l:
    buffer_load_dword v140, v15, s[32:35], s58 offen sc1
    s_waitcnt vmcnt(0)
    v_cmp_ne_u32 vcc, v2, v140
    s_nop 1
    s_cbranch_vccz Lback16
    s_add_u32 s59, s59, 1
    s_cmp_lt_u32 s59, 200000
    s_cbranch_scc1 Lspin16_l
    s_branch Lback16
Lspin17:
    s_mov_b32 s59, 0
Lspin17_l:
    buffer_load_dwordx4 v[104:107], v230, s[32:35], s57 offen sc1
    s_waitcnt vmcnt(0)
    v_cmp_ne_u32 vcc, v2, v105
    v_cmp_ne_u32 s[16:17], v2, v107
    s_nop 1
    s_or_b64 vcc, vcc, s[16:17]
    s_nop 1
    s_cbranch_vccz Lback17
    s_add_u32 s59, s59, 1
    s_cmp_lt_u32 s59, 200000
    s_cbranch_scc1 Lspin17_l
    s_branch Lback17
Lspin18:
    s_mov_b32 s59, 0
Lspin18_l:
    buffer_load_dword v90, v14, s[32:35], s1 offen sc1
    s_waitcnt vmcnt(0)
    v_cmp_ne_u32 vcc, v2, v90
    s_nop 1
    s_cbranch_vccz Lback18
    s_add_u32 s59, s59, 1
    s_cmp_lt_u32 s59, 200000
    s_cbranch_scc1 Lspin18_l
    s_branch Lback18
Lend:
    s_endpgm
Lhopend:
    s_mov_b64 exec, -1
    s_cmp_eq_u32 s99, 1
    s_cbranch_scc1 LretW
    s_branch LretC
.fill (65792-(.-adaLN_cond__ssm_conv_h3__glu_gated_reglu__prompt_kernel))/4, 4, 0xbf800000
.section .rodata,"a"
.p2align 6
.amdhsa_kernel adaLN_cond__ssm_conv_h3__glu_gated_reglu__prompt_kernel
  .amdhsa_next_free_vgpr 512
  .amdhsa_next_free_sgpr 102
  .amdhsa_accum_offset 256
  .amdhsa_group_segment_fixed_size 0
  .amdhsa_kernarg_size 120
  .amdhsa_user_sgpr_count 2
  .amdhsa_user_sgpr_kernarg_segment_ptr 1
  .amdhsa_system_sgpr_workgroup_id_x 1
  .amdhsa_float_denorm_mode_32 3
.end_amdhsa_kernel
```
